```python
import torch

def _softmax(x, axis=-1):
    return torch.softmax(x, dim=axis)
def _gelu(x):
    return torch.nn.functional.gelu(x, approximate="tanh")
def _silu(x):
    return torch.nn.functional.silu(x)
def _sigmoid(x):
    return torch.sigmoid(x)
def _layernorm(x, axis=-1, eps=1e-5):
    m = x.mean(dim=axis, keepdim=True)
    v = x.var(dim=axis, keepdim=True, unbiased=False)
    return (x - m) / torch.sqrt(v + eps)
def _scatter_add(tgt, idx, src, axis=0):
    return tgt.clone().index_add_(axis, idx, src)
def _segment_sum(src, seg, n):
    out = torch.zeros((n,) + src.shape[1:], dtype=src.dtype)
    return out.index_add_(0, seg, src)
def _pad(x, pw):
    flat = tuple(v for pair in reversed(pw) for v in pair)
    return torch.nn.functional.pad(x, flat)

kernel_name = 'sequential_preLN__gqa_block_cached__swiglu_ffn__decode'

def setup_inputs():

    _w = (lambda a: (lambda t: t.to(torch.bfloat16) if t.is_floating_point() else t)(torch.as_tensor(a)))
    def _A_setup():
        B, Sq, D = 4, 1, 512
        Hq, Hkv, Sk, Dh = 32, 8, 16384, 128
        assert Hq % Hkv == 0, (Hq, Hkv)
        return {
            "x": _w((lambda *s: torch.randn(*s, dtype=torch.bfloat16) * 0.05)(B, Sq, D)),
            "k_cache": _w((lambda *s: torch.randn(*s, dtype=torch.bfloat16) * 3.2)(B, Hkv, Sk, Dh)),
            "v_cache": _w((lambda *s: torch.randn(*s, dtype=torch.bfloat16) * 0.4)(B, Hkv, Sk, Dh)),
            "wq": _w((lambda *s: torch.randn(*s, dtype=torch.bfloat16) * 3.2)(D, Hq * Dh) * (D ** -0.5)),
            "wo": _w((lambda *s: torch.randn(*s, dtype=torch.bfloat16) * 0.4)(Hq * Dh, D) * ((Hq * Dh) ** -0.5)),
        }
    _A_in = _A_setup()

    def _B_setup():
        B, S, D, F = 4, 1, 512, 1792
        return {
            "x": _w((lambda *s: torch.randn(*s, dtype=torch.bfloat16) * 0.05)(B, S, D)),
            "w_gate": _w((lambda *s: torch.randn(*s, dtype=torch.bfloat16) * 0.05)(D, F)),
            "w_up": _w((lambda *s: torch.randn(*s, dtype=torch.bfloat16) * 0.05)(D, F)),
            "w_down": _w((lambda *s: torch.randn(*s, dtype=torch.bfloat16) * 0.05)(F, D)),
        }
    _B_in = _B_setup()

    return {
        "A_x": _A_in["x"],
        "A_k_cache": _A_in["k_cache"],
        "A_v_cache": _A_in["v_cache"],
        "A_wq": _A_in["wq"],
        "A_wo": _A_in["wo"],
        "B_x": _B_in["x"],
        "B_w_gate": _B_in["w_gate"],
        "B_w_up": _B_in["w_up"],
        "B_w_down": _B_in["w_down"],
    }

def reference(A_x, A_k_cache, A_v_cache, A_wq, A_wo, B_x, B_w_gate, B_w_up, B_w_down):
    def _A_ref(x, k_cache, v_cache, wq, wo):
        B, Sq, D = x.shape
        Hq, Dh = 32, 128
        Hkv = k_cache.shape[1]
        rep = Hq // Hkv
        q = (lambda x, *d: x.permute(*d))((x @ wq).reshape(B, Sq, Hq, Dh), 0, 2, 1, 3)
        k = (lambda x, n, axis: torch.repeat_interleave(x, n, dim=axis))(k_cache, rep, axis=1)
        v = (lambda x, n, axis: torch.repeat_interleave(x, n, dim=axis))(v_cache, rep, axis=1)
        scores = torch.einsum("bhqd,bhkd->bhqk", q, k) * (Dh ** -0.5)
        p = _softmax(scores, axis=-1)
        o = torch.einsum("bhqk,bhkd->bhqd", p, v)
        return (lambda x, *d: x.permute(*d))(o, 0, 2, 1, 3).reshape(B, Sq, Hq * Dh) @ wo

    def _B_ref(x, w_gate, w_up, w_down):
        g = _silu(x @ w_gate)
        u = x @ w_up
        return (g * u) @ w_down

    x = A_x
    h = x + _A_ref(_layernorm(x, axis=-1), A_k_cache, A_v_cache, A_wq, A_wo)
    h2 = h + _B_ref(_layernorm(h, axis=-1), B_w_gate, B_w_up, B_w_down)
    return h2
```

```asm
; @launch grid=(256,1,1) block=(256,1,1) lds=27648
.amdgcn_target "amdgcn-amd-amdhsa--gfx950"
.text
.p2align 8
.globl sequential_preLN__gqa_block_cached__swiglu_ffn__decode_kernel
.type sequential_preLN__gqa_block_cached__swiglu_ffn__decode_kernel,@function
sequential_preLN__gqa_block_cached__swiglu_ffn__decode_kernel:
  s_cmp_ge_u32 s2, 256
  s_cbranch_scc1 L_done
  s_load_dwordx8 s[4:11], s[0:1], 0
  s_load_dwordx2 s[12:13], s[0:1], 32
  s_load_dwordx4 s[16:19], s[0:1], 48
  s_load_dwordx4 s[20:23], s[0:1], 64
  s_load_dwordx4 s[24:27], s[0:1], 80
  v_lshrrev_b32 v2, 6, v0
  v_and_b32 v1, 63, v0
  v_readfirstlane_b32 s3, v2
  s_and_b32 s45, s2, 7
  s_lshr_b32 s46, s2, 3
  s_lshr_b32 s44, s46, 3
  s_and_b32 s42, s46, 7
  v_and_b32 v2, 15, v1
  v_lshrrev_b32 v3, 4, v1
  v_and_b32 v4, 3, v1
  v_lshrrev_b32 v5, 2, v1
  v_lshlrev_b32 v5, 6, v5
  v_lshl_add_u32 v5, v4, 10, v5
  v_lshlrev_b32 v6, 10, v4
  v_lshl_add_u32 v6, v3, 4, v6
  s_lshl_b32 s47, s44, 8
  s_lshl_b32 s48, s3, 6
  s_add_u32 s47, s47, s48
  v_add_u32 v6, s47, v6
  v_lshlrev_b32 v7, 16, v3
  v_lshl_add_u32 v7, v2, 3, v7
  s_lshl_b32 s47, s44, 20
  s_lshl_b32 s48, s3, 18
  s_add_u32 s47, s47, s48
  s_lshl_b32 s48, s42, 10
  s_add_u32 s47, s47, s48
  s_lshl_b32 s48, s45, 7
  s_add_u32 s47, s47, s48
  v_add_u32 v7, s47, v7
  v_lshrrev_b32 v8, 2, v2
  v_lshlrev_b32 v8, 8, v8
  v_lshl_add_u32 v8, v4, 4, v8
  v_lshl_add_u32 v8, v3, 6, v8
  v_lshlrev_b32 v9, 4, v1
  s_lshl_b32 s55, s46, 22
  s_lshl_b32 s64, s45, 2
  s_add_u32 s64, s64, s3
  s_mul_i32 s100, s46, 32
  s_and_b32 s100, s100, 511
  s_add_u32 s47, s64, s100
  s_and_b32 s47, s47, 511
  s_lshl_b32 s47, s47, 13
  s_add_u32 s36, s55, s47
  s_add_u32 s37, s36, 4096
  s_mov_b32 s101, 0
  s_mov_b32 s39, 0x3fb8aa3b
  s_mov_b32 s40, 0x05040100
  s_mov_b32 s41, 0x07060302
  s_mov_b32 s68, 0x3db504f3
  s_mov_b32 s69, 0x3db504f3
  s_mov_b32 s66, 0x3fb8aa3b
  s_mov_b32 s67, 0x3fb8aa3b
  s_mov_b32 s70, 0
  s_lshl_b32 s71, s46, 12
  s_add_u32 s71, s71, 3145728
  s_sub_u32 s47, s45, s46
  s_and_b32 s47, s47, 7
  s_mov_b32 s53, 0
  s_and_b32 s48, s47, 1
  s_cmp_eq_u32 s48, 1
  s_cbranch_scc1 L_role
  s_and_b32 s48, s47, 2
  s_cmp_eq_u32 s48, 0
  s_cbranch_scc0 L_roleCsel
  s_mov_b32 s53, 1
  s_lshr_b32 s48, s47, 2
  s_lshl_b32 s54, s46, 1
  s_add_u32 s54, s54, s48
  s_branch L_role
L_roleCsel:
  s_lshr_b32 s48, s47, 2
  s_lshl_b32 s54, s48, 2
  s_xor_b32 s54, s54, s46
  s_cmp_lt_u32 s54, 28
  s_cselect_b32 s53, 2, 0
  s_lshl_b32 s54, s54, 1
  s_add_u32 s54, s54, s48
L_role:
  s_waitcnt lgkmcnt(0)
  s_load_dword s52, s[26:27], 0
  s_mov_b32 s28, s6
  s_mov_b32 s29, s7
  s_mov_b32 s30, 134217728
  s_mov_b32 s31, 0x20000
  s_mov_b32 s32, s8
  s_mov_b32 s33, s9
  s_mov_b32 s34, 134217728
  s_mov_b32 s35, 0x20000
  s_mov_b32 s56, s10
  s_mov_b32 s57, s11
  s_mov_b32 s58, 0x400000
  s_mov_b32 s59, 0x20000
  global_load_dwordx4 v[16:19], v5, s[4:5] offset:0
  global_load_dwordx4 v[20:23], v5, s[4:5] offset:16
  global_load_dwordx4 v[24:27], v5, s[4:5] offset:32
  global_load_dwordx4 v[28:31], v5, s[4:5] offset:48
  global_load_dwordx4 v[32:35], v6, s[4:5]
  s_mov_b32 s48, 0
  buffer_load_dwordx2 v[48:49], v7, s[56:59], s48 offen nt
  s_mov_b32 s48, 8192
  buffer_load_dwordx2 v[50:51], v7, s[56:59], s48 offen nt
  s_mov_b32 s48, 16384
  buffer_load_dwordx2 v[52:53], v7, s[56:59], s48 offen nt
  s_mov_b32 s48, 24576
  buffer_load_dwordx2 v[54:55], v7, s[56:59], s48 offen nt
  s_mov_b32 s48, 32768
  buffer_load_dwordx2 v[56:57], v7, s[56:59], s48 offen nt
  s_mov_b32 s48, 40960
  buffer_load_dwordx2 v[58:59], v7, s[56:59], s48 offen nt
  s_mov_b32 s48, 49152
  buffer_load_dwordx2 v[60:61], v7, s[56:59], s48 offen nt
  s_mov_b32 s48, 57344
  buffer_load_dwordx2 v[62:63], v7, s[56:59], s48 offen nt
  buffer_load_dwordx4 a[0:3], v8, s[28:31], s36 offen offset:0 nt
  buffer_load_dwordx4 a[4:7], v8, s[28:31], s36 offen offset:1024 nt
  buffer_load_dwordx4 a[8:11], v8, s[28:31], s36 offen offset:2048 nt
  buffer_load_dwordx4 a[12:15], v8, s[28:31], s36 offen offset:3072 nt
  buffer_load_dwordx4 a[16:19], v8, s[28:31], s37 offen offset:0 nt
  buffer_load_dwordx4 a[20:23], v8, s[28:31], s37 offen offset:1024 nt
  buffer_load_dwordx4 a[24:27], v8, s[28:31], s37 offen offset:2048 nt
  buffer_load_dwordx4 a[28:31], v8, s[28:31], s37 offen offset:3072 nt
  s_waitcnt vmcnt(17)
  buffer_load_dwordx4 v[100:103], v9, s[32:35], s36 offen offset:0 nt
  buffer_load_dwordx4 v[104:107], v9, s[32:35], s36 offen offset:1024 nt
  buffer_load_dwordx4 v[108:111], v9, s[32:35], s36 offen offset:2048 nt
  buffer_load_dwordx4 v[112:115], v9, s[32:35], s36 offen offset:3072 nt
  buffer_load_dwordx4 v[116:119], v9, s[32:35], s37 offen offset:0 nt
  buffer_load_dwordx4 v[120:123], v9, s[32:35], s37 offen offset:1024 nt
  buffer_load_dwordx4 v[124:127], v9, s[32:35], s37 offen offset:2048 nt
  buffer_load_dwordx4 v[128:131], v9, s[32:35], s37 offen offset:3072 nt
  s_add_u32 s101, s101, 32
  s_add_u32 s47, s64, s101
  s_add_u32 s47, s47, s100
  s_and_b32 s47, s47, 511
  s_lshl_b32 s47, s47, 13
  s_add_u32 s36, s55, s47
  s_add_u32 s37, s36, 4096
  v_mov_b32 v10, 0x3f803f80
  v_mov_b32 v11, 0
  v_mov_b32 v12, 0
  v_mov_b32 v13, 0
  v_mov_b32 v14, 0
  v_dot2_f32_bf16 v11, v16, v10, v11
  v_dot2_f32_bf16 v12, v16, v16, v12
  v_dot2_f32_bf16 v13, v17, v10, v13
  v_dot2_f32_bf16 v14, v17, v17, v14
  v_dot2_f32_bf16 v11, v18, v10, v11
  v_dot2_f32_bf16 v12, v18, v18, v12
  v_dot2_f32_bf16 v13, v19, v10, v13
  v_dot2_f32_bf16 v14, v19, v19, v14
  v_dot2_f32_bf16 v11, v20, v10, v11
  v_dot2_f32_bf16 v12, v20, v20, v12
  v_dot2_f32_bf16 v13, v21, v10, v13
  v_dot2_f32_bf16 v14, v21, v21, v14
  v_dot2_f32_bf16 v11, v22, v10, v11
  v_dot2_f32_bf16 v12, v22, v22, v12
  v_dot2_f32_bf16 v13, v23, v10, v13
  v_dot2_f32_bf16 v14, v23, v23, v14
  v_dot2_f32_bf16 v11, v24, v10, v11
  v_dot2_f32_bf16 v12, v24, v24, v12
  v_dot2_f32_bf16 v13, v25, v10, v13
  v_dot2_f32_bf16 v14, v25, v25, v14
  v_dot2_f32_bf16 v11, v26, v10, v11
  v_dot2_f32_bf16 v12, v26, v26, v12
  v_dot2_f32_bf16 v13, v27, v10, v13
  v_dot2_f32_bf16 v14, v27, v27, v14
  v_dot2_f32_bf16 v11, v28, v10, v11
  v_dot2_f32_bf16 v12, v28, v28, v12
  v_dot2_f32_bf16 v13, v29, v10, v13
  v_dot2_f32_bf16 v14, v29, v29, v14
  v_dot2_f32_bf16 v11, v30, v10, v11
  v_dot2_f32_bf16 v12, v30, v30, v12
  v_dot2_f32_bf16 v13, v31, v10, v13
  v_dot2_f32_bf16 v14, v31, v31, v14
  s_nop 1
  v_add_f32 v11, v11, v13
  v_add_f32 v12, v12, v14
  s_nop 0
  v_add_f32_dpp v11, v11, v11 row_ror:4 row_mask:0xf bank_mask:0xf
  v_add_f32_dpp v12, v12, v12 row_ror:4 row_mask:0xf bank_mask:0xf
  s_nop 0
  v_add_f32_dpp v11, v11, v11 row_ror:8 row_mask:0xf bank_mask:0xf
  v_add_f32_dpp v12, v12, v12 row_ror:8 row_mask:0xf bank_mask:0xf
  v_mov_b32 v13, v11
  v_mov_b32 v14, v12
  s_nop 0
  v_permlane16_swap_b32 v11, v13
  v_permlane16_swap_b32 v12, v14
  v_add_f32 v11, v11, v13
  v_add_f32 v12, v12, v14
  v_mov_b32 v13, v11
  v_mov_b32 v14, v12
  s_nop 0
  v_permlane32_swap_b32 v11, v13
  v_permlane32_swap_b32 v12, v14
  v_add_f32 v11, v11, v13
  v_add_f32 v12, v12, v14
  v_mul_f32 v11, 0x3b000000, v11
  v_mul_f32 v12, 0x3b000000, v12
  v_fma_f32 v12, -v11, v11, v12
  v_cvt_pk_bf16_f32 v13, v11, v12
  v_lshlrev_b32 v10, 16, v13
  v_and_b32 v12, 0xffff0000, v13
  v_add_f32 v12, 0x3727c5ac, v12
  v_cvt_pk_bf16_f32 v12, v12, v12
  v_lshlrev_b32 v12, 16, v12
  v_sqrt_f32 v12, v12
  s_nop 0
  v_cvt_pk_bf16_f32 v12, v12, v12
  v_lshlrev_b32 v12, 16, v12
  v_rcp_f32 v12, v12
  v_sub_f32 v10, 0, v10
  v_mov_b32 v11, v10
  v_mov_b32 v13, v12
  s_waitcnt vmcnt(24)
  v_lshlrev_b32 v14, 16, v32
  v_and_b32 v15, 0xffff0000, v32
  v_pk_add_f32 v[14:15], v[14:15], v[10:11]
  v_cvt_pk_bf16_f32 v32, v14, v15
  v_lshlrev_b32 v16, 16, v32
  v_and_b32 v17, 0xffff0000, v32
  v_pk_mul_f32 v[16:17], v[16:17], v[12:13]
  v_cvt_pk_bf16_f32 v32, v16, v17
  v_lshlrev_b32 v14, 16, v33
  v_and_b32 v15, 0xffff0000, v33
  v_pk_add_f32 v[14:15], v[14:15], v[10:11]
  v_cvt_pk_bf16_f32 v33, v14, v15
  v_lshlrev_b32 v16, 16, v33
  v_and_b32 v17, 0xffff0000, v33
  v_pk_mul_f32 v[16:17], v[16:17], v[12:13]
  v_cvt_pk_bf16_f32 v33, v16, v17
  v_lshlrev_b32 v14, 16, v34
  v_and_b32 v15, 0xffff0000, v34
  v_pk_add_f32 v[14:15], v[14:15], v[10:11]
  v_cvt_pk_bf16_f32 v34, v14, v15
  v_lshlrev_b32 v16, 16, v34
  v_and_b32 v17, 0xffff0000, v34
  v_pk_mul_f32 v[16:17], v[16:17], v[12:13]
  v_cvt_pk_bf16_f32 v34, v16, v17
  v_lshlrev_b32 v14, 16, v35
  v_and_b32 v15, 0xffff0000, v35
  v_pk_add_f32 v[14:15], v[14:15], v[10:11]
  v_cvt_pk_bf16_f32 v35, v14, v15
  v_lshlrev_b32 v16, 16, v35
  v_and_b32 v17, 0xffff0000, v35
  v_pk_mul_f32 v[16:17], v[16:17], v[12:13]
  v_cvt_pk_bf16_f32 v35, v16, v17
  s_waitcnt vmcnt(16)
  v_perm_b32 v64, v50, v48, s40
  v_perm_b32 v65, v54, v52, s40
  v_perm_b32 v66, v58, v56, s40
  v_perm_b32 v67, v62, v60, s40
  v_perm_b32 v68, v50, v48, s41
  v_perm_b32 v69, v54, v52, s41
  v_perm_b32 v70, v58, v56, s41
  v_perm_b32 v71, v62, v60, s41
  v_perm_b32 v72, v51, v49, s40
  v_perm_b32 v73, v55, v53, s40
  v_perm_b32 v74, v59, v57, s40
  v_perm_b32 v75, v63, v61, s40
  v_perm_b32 v76, v51, v49, s41
  v_perm_b32 v77, v55, v53, s41
  v_perm_b32 v78, v59, v57, s41
  v_perm_b32 v79, v63, v61, s41
  v_mfma_f32_16x16x32_bf16 v[16:19], v[32:35], v[64:67], 0
  v_mfma_f32_16x16x32_bf16 v[20:23], v[32:35], v[68:71], 0
  v_mfma_f32_16x16x32_bf16 v[24:27], v[32:35], v[72:75], 0
  v_mfma_f32_16x16x32_bf16 v[28:31], v[32:35], v[76:79], 0
  s_lshl_b32 s48, s3, 10
  v_lshlrev_b32 v10, 4, v1
  v_add_u32 v10, s48, v10
  s_mov_b64 exec, 0xffff
  s_nop 0
  ds_write_b128 v10, v[16:19] offset:0
  ds_write_b128 v10, v[20:23] offset:256
  ds_write_b128 v10, v[24:27] offset:512
  ds_write_b128 v10, v[28:31] offset:768
  s_mov_b64 exec, -1
  v_and_b32 v10, 3, v1
  v_lshlrev_b32 v10, 8, v10
  v_lshrrev_b32 v11, 2, v1
  v_lshl_add_u32 v10, v11, 4, v10
  s_lshl_b32 s48, s3, 2
  v_add_u32 v10, s48, v10
  s_lshl_b32 s47, s44, 17
  s_lshl_b32 s48, s3, 15
  s_add_u32 s47, s47, s48
  s_lshl_b32 s48, s42, 12
  s_add_u32 s47, s47, s48
  s_lshl_b32 s48, s45, 9
  s_add_u32 s47, s47, s48
  s_add_u32 s47, s47, 65536
  v_lshl_add_u32 v15, v1, 3, s47
  s_waitcnt lgkmcnt(0)
  s_barrier
  ds_read_b32 v11, v10 offset:0
  ds_read_b32 v12, v10 offset:1024
  ds_read_b32 v13, v10 offset:2048
  ds_read_b32 v14, v10 offset:3072
  s_add_u32 s52, s52, 1
  s_waitcnt lgkmcnt(0)
  v_add_f32 v11, v11, v12
  v_add_f32 v13, v13, v14
  v_add_f32 v20, v11, v13
  v_mov_b32 v21, s52
  v_mov_b32 v23, s52
  v_mov_b32_dpp v22, v20 quad_perm:[1,0,3,2] row_mask:0xf bank_mask:0xf
  s_mov_b32 s50, 0x55555555
  s_mov_b32 s51, 0x55555555
  s_mov_b64 exec, s[50:51]
  global_store_dwordx4 v15, v[20:23], s[26:27] sc1
  s_mov_b64 exec, -1
  s_lshl_b32 s47, s3, 17
  s_lshl_b32 s48, s44, 15
  s_add_u32 s47, s47, s48
  s_lshl_b32 s48, s42, 12
  s_add_u32 s47, s47, s48
  s_add_u32 s47, s47, 65536
  v_lshl_add_u32 v10, v1, 4, s47
  v_lshlrev_b32 v11, 9, v4
  v_lshl_add_u32 v11, v3, 7, v11
  v_lshrrev_b32 v12, 2, v2
  v_lshl_add_u32 v11, v12, 5, v11
  v_mov_b32 v2, v8
  v_mov_b32 v3, v9
  v_mov_b32 v40, -1
  v_mov_b32 v41, -1
  v_mov_b32 v42, -1
  v_mov_b32 v43, -1
  s_lshl_b32 s48, s42, 15
  s_lshl_b32 s47, s3, 13
  s_add_u32 s48, s48, s47
  s_lshl_b32 s47, s45, 10
  s_add_u32 s48, s48, s47
  s_lshl_b32 s47, s44, 8
  s_add_u32 s48, s48, s47
  s_add_u32 s48, s48, 1048576
  v_lshl_add_u32 v14, v1, 4, s48
  s_mov_b64 exec, 0xffff
  global_store_dwordx4 v14, v[40:43], s[26:27] sc1
  s_lshl_b32 s48, s42, 12
  s_lshl_b32 s47, s3, 10
  s_add_u32 s48, s48, s47
  s_lshl_b32 s47, s45, 7
  s_add_u32 s48, s48, s47
  s_lshl_b32 s47, s44, 2
  s_add_u32 s48, s48, s47
  s_add_u32 s48, s48, 1572864
  v_mov_b32 v14, s48
  s_mov_b64 exec, 1
  global_store_dword v14, v40, s[26:27] sc1
  s_or_b32 s47, s45, s3
  s_cmp_lg_u32 s47, 0
  s_cbranch_scc1 L_clr0
  v_mov_b32 v14, s71
  v_mov_b32 v15, 0
  global_store_dword v14, v15, s[26:27] sc1
L_clr0:
  s_mov_b64 exec, -1
  s_cmp_eq_u32 s53, 1
  s_cbranch_scc0 L_clr1
  s_lshr_b32 s48, s54, 3
  s_lshl_b32 s48, s48, 10
  s_and_b32 s47, s54, 7
  s_lshr_b32 s43, s47, 1
  s_lshl_b32 s43, s43, 13
  s_add_u32 s48, s48, s43
  s_and_b32 s47, s47, 1
  s_lshl_b32 s47, s47, 7
  s_add_u32 s48, s48, s47
  s_lshl_b32 s47, s3, 8
  s_add_u32 s48, s48, s47
  s_add_u32 s48, s48, 1703936
  v_lshl_add_u32 v14, v1, 4, s48
  s_mov_b64 exec, 0xff
  global_store_dwordx4 v14, v[40:43], s[26:27] sc1
  s_mov_b64 exec, -1
L_clr1:
  s_cmp_eq_u32 s53, 2
  s_cbranch_scc0 L_clr2
  s_lshl_b32 s48, s54, 13
  s_lshl_b32 s47, s3, 11
  s_add_u32 s48, s48, s47
  s_add_u32 s48, s48, 2097152
  v_lshl_add_u32 v14, v1, 4, s48
  global_store_dwordx4 v14, v[40:43], s[26:27] sc1
  global_store_dwordx4 v14, v[40:43], s[26:27] offset:1024 sc1
L_clr2:
  buffer_load_dwordx4 a[32:35], v2, s[28:31], s36 offen offset:0 nt
  buffer_load_dwordx4 a[36:39], v2, s[28:31], s36 offen offset:1024 nt
  buffer_load_dwordx4 a[40:43], v2, s[28:31], s36 offen offset:2048 nt
  buffer_load_dwordx4 a[44:47], v2, s[28:31], s36 offen offset:3072 nt
  buffer_load_dwordx4 a[48:51], v2, s[28:31], s37 offen offset:0 nt
  buffer_load_dwordx4 a[52:55], v2, s[28:31], s37 offen offset:1024 nt
  buffer_load_dwordx4 a[56:59], v2, s[28:31], s37 offen offset:2048 nt
  buffer_load_dwordx4 a[60:63], v2, s[28:31], s37 offen offset:3072 nt
  buffer_load_dwordx4 v[132:135], v3, s[32:35], s36 offen offset:0 nt
  buffer_load_dwordx4 v[136:139], v3, s[32:35], s36 offen offset:1024 nt
  buffer_load_dwordx4 v[140:143], v3, s[32:35], s36 offen offset:2048 nt
  buffer_load_dwordx4 v[144:147], v3, s[32:35], s36 offen offset:3072 nt
  buffer_load_dwordx4 v[148:151], v3, s[32:35], s37 offen offset:0 nt
  buffer_load_dwordx4 v[152:155], v3, s[32:35], s37 offen offset:1024 nt
  buffer_load_dwordx4 v[156:159], v3, s[32:35], s37 offen offset:2048 nt
  buffer_load_dwordx4 v[160:163], v3, s[32:35], s37 offen offset:3072 nt
  global_load_dwordx4 v[16:19], v10, s[26:27] offset:0 sc1
  global_load_dwordx4 v[20:23], v10, s[26:27] offset:1024 sc1
  global_load_dwordx4 v[24:27], v10, s[26:27] offset:2048 sc1
  global_load_dwordx4 v[28:31], v10, s[26:27] offset:3072 sc1
  s_add_u32 s101, s101, 32
  s_add_u32 s47, s64, s101
  s_add_u32 s47, s47, s100
  s_and_b32 s47, s47, 511
  s_lshl_b32 s47, s47, 13
  s_add_u32 s36, s55, s47
  s_add_u32 s37, s36, 4096
  buffer_load_dwordx4 a[64:67], v2, s[28:31], s36 offen offset:0 nt
  buffer_load_dwordx4 a[68:71], v2, s[28:31], s36 offen offset:1024 nt
  buffer_load_dwordx4 a[72:75], v2, s[28:31], s36 offen offset:2048 nt
  buffer_load_dwordx4 a[76:79], v2, s[28:31], s36 offen offset:3072 nt
  buffer_load_dwordx4 a[80:83], v2, s[28:31], s37 offen offset:0 nt
  buffer_load_dwordx4 a[84:87], v2, s[28:31], s37 offen offset:1024 nt
  buffer_load_dwordx4 a[88:91], v2, s[28:31], s37 offen offset:2048 nt
  buffer_load_dwordx4 a[92:95], v2, s[28:31], s37 offen offset:3072 nt
  v_mov_b32 v8, 0xff800000
  v_mov_b32 v12, 0
  v_mov_b32 v13, 0
  v_mov_b32 v52, 0
  v_mov_b32 v53, 0
  v_mov_b32 v54, 0
  v_mov_b32 v55, 0
  v_mov_b32 v56, 0
  v_mov_b32 v57, 0
  v_mov_b32 v58, 0
  v_mov_b32 v59, 0
  v_mov_b32 v60, 0
  v_mov_b32 v61, 0
  v_mov_b32 v62, 0
  v_mov_b32 v63, 0
  v_mov_b32 v64, 0
  v_mov_b32 v65, 0
  v_mov_b32 v66, 0
  v_mov_b32 v67, 0
  v_mov_b32 v68, 0
  v_mov_b32 v69, 0
  v_mov_b32 v70, 0
  v_mov_b32 v71, 0
  v_mov_b32 v72, 0
  v_mov_b32 v73, 0
  v_mov_b32 v74, 0
  v_mov_b32 v75, 0
  v_mov_b32 v76, 0
  v_mov_b32 v77, 0
  v_mov_b32 v78, 0
  v_mov_b32 v79, 0
  v_mov_b32 v80, 0
  v_mov_b32 v81, 0
  v_mov_b32 v82, 0
  v_mov_b32 v83, 0
  s_mov_b32 s65, 262144
  s_waitcnt vmcnt(8)
L_qchk:
  v_min3_u32 v32, v17, v19, v21
  v_max3_u32 v33, v17, v19, v21
  v_min3_u32 v32, v32, v23, v25
  v_max3_u32 v33, v33, v23, v25
  v_min3_u32 v32, v32, v27, v29
  v_max3_u32 v33, v33, v27, v29
  v_min_u32 v32, v32, v31
  v_max_u32 v33, v33, v31
  v_cmp_eq_u32 s[50:51], s52, v32
  v_cmp_eq_u32 vcc, s52, v33
  s_nop 0
  s_and_b64 s[50:51], s[50:51], vcc
  s_cmp_eq_u64 s[50:51], -1
  s_cbranch_scc1 L_qok
  s_sub_u32 s65, s65, 1
  s_cmp_eq_u32 s65, 0
  s_cbranch_scc1 L_qok
  global_load_dwordx4 v[16:19], v10, s[26:27] offset:0 sc1
  global_load_dwordx4 v[20:23], v10, s[26:27] offset:1024 sc1
  global_load_dwordx4 v[24:27], v10, s[26:27] offset:2048 sc1
  global_load_dwordx4 v[28:31], v10, s[26:27] offset:3072 sc1
  s_waitcnt vmcnt(0)
  s_branch L_qchk
L_qok:
  v_mov_b32 v17, v18
  v_mov_b32 v21, v22
  v_mov_b32 v25, v26
  v_mov_b32 v29, v30
  s_lshl_b32 s47, s3, 11
  v_lshl_add_u32 v32, v1, 3, s47
  ds_write_b64 v32, v[16:17] offset:4096
  ds_write_b64 v32, v[20:21] offset:4608
  ds_write_b64 v32, v[24:25] offset:5120
  ds_write_b64 v32, v[28:29] offset:5632
  s_waitcnt lgkmcnt(0)
  s_barrier
  s_cmp_lg_u32 s3, 0
  s_cbranch_scc1 L_sig0
  v_mov_b32 v48, 0
  v_mov_b32 v49, 1
  s_mov_b64 exec, 1
  global_atomic_add v48, v49, s[24:25]
  s_mov_b64 exec, -1
L_sig0:
  ds_read_b128 v[16:19], v11 offset:4096
  ds_read_b128 v[20:23], v11 offset:4112
  ds_read_b128 v[24:27], v11 offset:6144
  ds_read_b128 v[28:31], v11 offset:6160
  ds_read_b128 v[32:35], v11 offset:8192
  ds_read_b128 v[36:39], v11 offset:8208
  ds_read_b128 v[40:43], v11 offset:10240
  ds_read_b128 v[44:47], v11 offset:10256
  s_waitcnt lgkmcnt(0)
  v_pk_add_f32 v[16:17], v[16:17], v[24:25]
  v_pk_add_f32 v[32:33], v[32:33], v[40:41]
  v_pk_add_f32 v[16:17], v[16:17], v[32:33]
  v_pk_add_f32 v[18:19], v[18:19], v[26:27]
  v_pk_add_f32 v[34:35], v[34:35], v[42:43]
  v_pk_add_f32 v[18:19], v[18:19], v[34:35]
  v_pk_add_f32 v[20:21], v[20:21], v[28:29]
  v_pk_add_f32 v[36:37], v[36:37], v[44:45]
  v_pk_add_f32 v[20:21], v[20:21], v[36:37]
  v_pk_add_f32 v[22:23], v[22:23], v[30:31]
  v_pk_add_f32 v[38:39], v[38:39], v[46:47]
  v_pk_add_f32 v[22:23], v[22:23], v[38:39]
  v_cvt_pk_bf16_f32 v4, v16, v17
  v_cvt_pk_bf16_f32 v5, v18, v19
  v_cvt_pk_bf16_f32 v6, v20, v21
  v_cvt_pk_bf16_f32 v7, v22, v23
  buffer_load_dwordx4 v[164:167], v3, s[32:35], s36 offen offset:0 nt
  buffer_load_dwordx4 v[168:171], v3, s[32:35], s36 offen offset:1024 nt
  buffer_load_dwordx4 v[172:175], v3, s[32:35], s36 offen offset:2048 nt
  buffer_load_dwordx4 v[176:179], v3, s[32:35], s36 offen offset:3072 nt
  buffer_load_dwordx4 v[180:183], v3, s[32:35], s37 offen offset:0 nt
  buffer_load_dwordx4 v[184:187], v3, s[32:35], s37 offen offset:1024 nt
  buffer_load_dwordx4 v[188:191], v3, s[32:35], s37 offen offset:2048 nt
  buffer_load_dwordx4 v[192:195], v3, s[32:35], s37 offen offset:3072 nt
  s_branch L_wl1
  s_cmp_eq_u32 s53, 1
  s_cbranch_scc0 L_wl1
  v_and_b32 v11, 15, v1
  v_lshrrev_b32 v14, 4, v1
  v_lshlrev_b32 v15, 11, v14
  v_lshl_add_u32 v15, v11, 3, v15
  s_lshr_b32 s48, s54, 3
  s_lshl_b32 s48, s48, 19
  s_lshl_b32 s47, s3, 17
  s_add_u32 s48, s48, s47
  s_and_b32 s47, s54, 7
  s_lshl_b32 s47, s47, 7
  s_add_u32 s48, s48, s47
  v_add_u32 v15, s48, v15
  s_mov_b32 s56, s12
  s_mov_b32 s57, s13
  s_mov_b32 s58, 0x400000
  s_mov_b32 s59, 0x20000
  s_mov_b32 s48, 0
  buffer_load_dwordx2 a[96:97], v15, s[56:59], s48 offen nt
  s_mov_b32 s48, 8192
  buffer_load_dwordx2 a[98:99], v15, s[56:59], s48 offen nt
  s_mov_b32 s48, 16384
  buffer_load_dwordx2 a[100:101], v15, s[56:59], s48 offen nt
  s_mov_b32 s48, 24576
  buffer_load_dwordx2 a[102:103], v15, s[56:59], s48 offen nt
  s_mov_b32 s48, 1024
  buffer_load_dwordx2 a[104:105], v15, s[56:59], s48 offen nt
  s_mov_b32 s48, 9216
  buffer_load_dwordx2 a[106:107], v15, s[56:59], s48 offen nt
  s_mov_b32 s48, 17408
  buffer_load_dwordx2 a[108:109], v15, s[56:59], s48 offen nt
  s_mov_b32 s48, 25600
  buffer_load_dwordx2 a[110:111], v15, s[56:59], s48 offen nt
  s_mov_b32 s48, 32768
  buffer_load_dwordx2 a[112:113], v15, s[56:59], s48 offen nt
  s_mov_b32 s48, 40960
  buffer_load_dwordx2 a[114:115], v15, s[56:59], s48 offen nt
  s_mov_b32 s48, 49152
  buffer_load_dwordx2 a[116:117], v15, s[56:59], s48 offen nt
  s_mov_b32 s48, 57344
  buffer_load_dwordx2 a[118:119], v15, s[56:59], s48 offen nt
  s_mov_b32 s48, 33792
  buffer_load_dwordx2 a[120:121], v15, s[56:59], s48 offen nt
  s_mov_b32 s48, 41984
  buffer_load_dwordx2 a[122:123], v15, s[56:59], s48 offen nt
  s_mov_b32 s48, 50176
  buffer_load_dwordx2 a[124:125], v15, s[56:59], s48 offen nt
  s_mov_b32 s48, 58368
  buffer_load_dwordx2 a[126:127], v15, s[56:59], s48 offen nt
  s_mov_b32 s48, 65536
  buffer_load_dwordx2 a[128:129], v15, s[56:59], s48 offen nt
  s_mov_b32 s48, 73728
  buffer_load_dwordx2 a[130:131], v15, s[56:59], s48 offen nt
  s_mov_b32 s48, 81920
  buffer_load_dwordx2 a[132:133], v15, s[56:59], s48 offen nt
  s_mov_b32 s48, 90112
  buffer_load_dwordx2 a[134:135], v15, s[56:59], s48 offen nt
  s_mov_b32 s48, 66560
  buffer_load_dwordx2 a[136:137], v15, s[56:59], s48 offen nt
  s_mov_b32 s48, 74752
  buffer_load_dwordx2 a[138:139], v15, s[56:59], s48 offen nt
  s_mov_b32 s48, 82944
  buffer_load_dwordx2 a[140:141], v15, s[56:59], s48 offen nt
  s_mov_b32 s48, 91136
  buffer_load_dwordx2 a[142:143], v15, s[56:59], s48 offen nt
  s_mov_b32 s48, 98304
  buffer_load_dwordx2 a[144:145], v15, s[56:59], s48 offen nt
  s_mov_b32 s48, 106496
  buffer_load_dwordx2 a[146:147], v15, s[56:59], s48 offen nt
  s_mov_b32 s48, 114688
  buffer_load_dwordx2 a[148:149], v15, s[56:59], s48 offen nt
  s_mov_b32 s48, 122880
  buffer_load_dwordx2 a[150:151], v15, s[56:59], s48 offen nt
  s_mov_b32 s48, 99328
  buffer_load_dwordx2 a[152:153], v15, s[56:59], s48 offen nt
  s_mov_b32 s48, 107520
  buffer_load_dwordx2 a[154:155], v15, s[56:59], s48 offen nt
  s_mov_b32 s48, 115712
  buffer_load_dwordx2 a[156:157], v15, s[56:59], s48 offen nt
  s_mov_b32 s48, 123904
  buffer_load_dwordx2 a[158:159], v15, s[56:59], s48 offen nt
L_wl1:
  s_branch L_wl2
  s_cmp_eq_u32 s53, 2
  s_cbranch_scc0 L_wl2
  v_and_b32 v11, 15, v1
  v_lshrrev_b32 v14, 4, v1
  v_mul_u32_u24 v15, 28672, v14
  v_lshl_add_u32 v15, v11, 2, v15
  s_mul_i32 s48, s3, 458752
  s_lshl_b32 s47, s54, 6
  s_add_u32 s48, s48, s47
  v_add_u32 v15, s48, v15
  s_mov_b32 s56, s16
  s_mov_b32 s57, s17
  s_mov_b32 s58, 1835008
  s_mov_b32 s59, 0x20000
  s_mov_b32 s60, s18
  s_mov_b32 s61, s19
  s_mov_b32 s62, 1835008
  s_mov_b32 s63, 0x20000
  s_mov_b32 s48, 0
  buffer_load_dword a96, v15, s[56:59], s48 offen nt
  s_mov_b32 s48, 3584
  buffer_load_dword a97, v15, s[56:59], s48 offen nt
  s_mov_b32 s48, 7168
  buffer_load_dword a98, v15, s[56:59], s48 offen nt
  s_mov_b32 s48, 10752
  buffer_load_dword a99, v15, s[56:59], s48 offen nt
  s_mov_b32 s48, 14336
  buffer_load_dword a100, v15, s[56:59], s48 offen nt
  s_mov_b32 s48, 17920
  buffer_load_dword a101, v15, s[56:59], s48 offen nt
  s_mov_b32 s48, 21504
  buffer_load_dword a102, v15, s[56:59], s48 offen nt
  s_mov_b32 s48, 25088
  buffer_load_dword a103, v15, s[56:59], s48 offen nt
  s_mov_b32 s48, 114688
  buffer_load_dword a104, v15, s[56:59], s48 offen nt
  s_mov_b32 s48, 118272
  buffer_load_dword a105, v15, s[56:59], s48 offen nt
  s_mov_b32 s48, 121856
  buffer_load_dword a106, v15, s[56:59], s48 offen nt
  s_mov_b32 s48, 125440
  buffer_load_dword a107, v15, s[56:59], s48 offen nt
  s_mov_b32 s48, 129024
  buffer_load_dword a108, v15, s[56:59], s48 offen nt
  s_mov_b32 s48, 132608
  buffer_load_dword a109, v15, s[56:59], s48 offen nt
  s_mov_b32 s48, 136192
  buffer_load_dword a110, v15, s[56:59], s48 offen nt
  s_mov_b32 s48, 139776
  buffer_load_dword a111, v15, s[56:59], s48 offen nt
  s_mov_b32 s48, 229376
  buffer_load_dword a112, v15, s[56:59], s48 offen nt
  s_mov_b32 s48, 232960
  buffer_load_dword a113, v15, s[56:59], s48 offen nt
  s_mov_b32 s48, 236544
  buffer_load_dword a114, v15, s[56:59], s48 offen nt
  s_mov_b32 s48, 240128
  buffer_load_dword a115, v15, s[56:59], s48 offen nt
  s_mov_b32 s48, 243712
  buffer_load_dword a116, v15, s[56:59], s48 offen nt
  s_mov_b32 s48, 247296
  buffer_load_dword a117, v15, s[56:59], s48 offen nt
  s_mov_b32 s48, 250880
  buffer_load_dword a118, v15, s[56:59], s48 offen nt
  s_mov_b32 s48, 254464
  buffer_load_dword a119, v15, s[56:59], s48 offen nt
  s_mov_b32 s48, 344064
  buffer_load_dword a120, v15, s[56:59], s48 offen nt
  s_mov_b32 s48, 347648
  buffer_load_dword a121, v15, s[56:59], s48 offen nt
  s_mov_b32 s48, 351232
  buffer_load_dword a122, v15, s[56:59], s48 offen nt
  s_mov_b32 s48, 354816
  buffer_load_dword a123, v15, s[56:59], s48 offen nt
  s_mov_b32 s48, 358400
  buffer_load_dword a124, v15, s[56:59], s48 offen nt
  s_mov_b32 s48, 361984
  buffer_load_dword a125, v15, s[56:59], s48 offen nt
  s_mov_b32 s48, 365568
  buffer_load_dword a126, v15, s[56:59], s48 offen nt
  s_mov_b32 s48, 369152
  buffer_load_dword a127, v15, s[56:59], s48 offen nt
  s_mov_b32 s48, 0
  buffer_load_dword a128, v15, s[60:63], s48 offen nt
  s_mov_b32 s48, 3584
  buffer_load_dword a129, v15, s[60:63], s48 offen nt
  s_mov_b32 s48, 7168
  buffer_load_dword a130, v15, s[60:63], s48 offen nt
  s_mov_b32 s48, 10752
  buffer_load_dword a131, v15, s[60:63], s48 offen nt
  s_mov_b32 s48, 14336
  buffer_load_dword a132, v15, s[60:63], s48 offen nt
  s_mov_b32 s48, 17920
  buffer_load_dword a133, v15, s[60:63], s48 offen nt
  s_mov_b32 s48, 21504
  buffer_load_dword a134, v15, s[60:63], s48 offen nt
  s_mov_b32 s48, 25088
  buffer_load_dword a135, v15, s[60:63], s48 offen nt
  s_mov_b32 s48, 114688
  buffer_load_dword a136, v15, s[60:63], s48 offen nt
  s_mov_b32 s48, 118272
  buffer_load_dword a137, v15, s[60:63], s48 offen nt
  s_mov_b32 s48, 121856
  buffer_load_dword a138, v15, s[60:63], s48 offen nt
  s_mov_b32 s48, 125440
  buffer_load_dword a139, v15, s[60:63], s48 offen nt
  s_mov_b32 s48, 129024
  buffer_load_dword a140, v15, s[60:63], s48 offen nt
  s_mov_b32 s48, 132608
  buffer_load_dword a141, v15, s[60:63], s48 offen nt
  s_mov_b32 s48, 136192
  buffer_load_dword a142, v15, s[60:63], s48 offen nt
  s_mov_b32 s48, 139776
  buffer_load_dword a143, v15, s[60:63], s48 offen nt
  s_mov_b32 s48, 229376
  buffer_load_dword a144, v15, s[60:63], s48 offen nt
  s_mov_b32 s48, 232960
  buffer_load_dword a145, v15, s[60:63], s48 offen nt
  s_mov_b32 s48, 236544
  buffer_load_dword a146, v15, s[60:63], s48 offen nt
  s_mov_b32 s48, 240128
  buffer_load_dword a147, v15, s[60:63], s48 offen nt
  s_mov_b32 s48, 243712
  buffer_load_dword a148, v15, s[60:63], s48 offen nt
  s_mov_b32 s48, 247296
  buffer_load_dword a149, v15, s[60:63], s48 offen nt
  s_mov_b32 s48, 250880
  buffer_load_dword a150, v15, s[60:63], s48 offen nt
  s_mov_b32 s48, 254464
  buffer_load_dword a151, v15, s[60:63], s48 offen nt
  s_mov_b32 s48, 344064
  buffer_load_dword a152, v15, s[60:63], s48 offen nt
  s_mov_b32 s48, 347648
  buffer_load_dword a153, v15, s[60:63], s48 offen nt
  s_mov_b32 s48, 351232
  buffer_load_dword a154, v15, s[60:63], s48 offen nt
  s_mov_b32 s48, 354816
  buffer_load_dword a155, v15, s[60:63], s48 offen nt
  s_mov_b32 s48, 358400
  buffer_load_dword a156, v15, s[60:63], s48 offen nt
  s_mov_b32 s48, 361984
  buffer_load_dword a157, v15, s[60:63], s48 offen nt
  s_mov_b32 s48, 365568
  buffer_load_dword a158, v15, s[60:63], s48 offen nt
  s_mov_b32 s48, 369152
  buffer_load_dword a159, v15, s[60:63], s48 offen nt
  v_lshlrev_b32 v15, 13, v14
  v_lshl_add_u32 v15, v11, 4, v15
  s_lshl_b32 s48, s54, 15
  s_lshl_b32 s47, s3, 8
  s_add_u32 s48, s48, s47
  v_add_u32 v15, s48, v15
  v_add_u32 v10, 0x1000, v15
  global_load_dwordx4 a[160:163], v15, s[20:21] offset:0 nt
  global_load_dwordx4 a[164:167], v15, s[20:21] offset:1024 nt
  global_load_dwordx4 a[168:171], v15, s[20:21] offset:2048 nt
  global_load_dwordx4 a[172:175], v15, s[20:21] offset:3072 nt
  global_load_dwordx4 a[176:179], v10, s[20:21] offset:0 nt
  global_load_dwordx4 a[180:183], v10, s[20:21] offset:1024 nt
  global_load_dwordx4 a[184:187], v10, s[20:21] offset:2048 nt
  global_load_dwordx4 a[188:191], v10, s[20:21] offset:3072 nt
  v_lshlrev_b32 v15, 10, v14
  v_lshl_add_u32 v15, v11, 4, v15
  s_lshl_b32 s47, s3, 8
  v_add_u32 v15, s47, v15
  global_load_dwordx4 v[196:199], v15, s[4:5]
L_wl2:
  v_mov_b32 v248, s71
  v_mov_b32 v249, 1
  s_mov_b32 s49, 0
  v_mfma_f32_16x16x32_bf16 v[20:23], a[0:3], v[4:7], 0
  v_mfma_f32_16x16x32_bf16 v[24:27], a[4:7], v[4:7], 0
  v_mfma_f32_16x16x32_bf16 v[28:31], a[8:11], v[4:7], 0
  v_mfma_f32_16x16x32_bf16 v[32:35], a[12:15], v[4:7], 0
  v_mfma_f32_16x16x32_bf16 v[36:39], a[16:19], v[4:7], 0
  v_mfma_f32_16x16x32_bf16 v[40:43], a[20:23], v[4:7], 0
  v_mfma_f32_16x16x32_bf16 v[44:47], a[24:27], v[4:7], 0
  v_mfma_f32_16x16x32_bf16 v[48:51], a[28:31], v[4:7], 0
  s_nop 0
  v_add_f32_dpp v20, v21, v20 row_shl:4 row_mask:0xf bank_mask:0x1
  v_add_f32_dpp v24, v25, v24 row_shl:4 row_mask:0xf bank_mask:0x1
  v_add_f32_dpp v28, v29, v28 row_shl:4 row_mask:0xf bank_mask:0x1
  v_add_f32_dpp v32, v33, v32 row_shl:4 row_mask:0xf bank_mask:0x1
  v_add_f32_dpp v36, v37, v36 row_shl:4 row_mask:0xf bank_mask:0x1
  v_add_f32_dpp v40, v41, v40 row_shl:4 row_mask:0xf bank_mask:0x1
  v_add_f32_dpp v44, v45, v44 row_shl:4 row_mask:0xf bank_mask:0x1
  v_add_f32_dpp v48, v49, v48 row_shl:4 row_mask:0xf bank_mask:0x1
  v_add_f32_dpp v20, v22, v20 row_shl:8 row_mask:0xf bank_mask:0x1
  v_add_f32_dpp v24, v26, v24 row_shl:8 row_mask:0xf bank_mask:0x1
  v_add_f32_dpp v28, v30, v28 row_shl:8 row_mask:0xf bank_mask:0x1
  v_add_f32_dpp v32, v34, v32 row_shl:8 row_mask:0xf bank_mask:0x1
  v_add_f32_dpp v36, v38, v36 row_shl:8 row_mask:0xf bank_mask:0x1
  v_add_f32_dpp v40, v42, v40 row_shl:8 row_mask:0xf bank_mask:0x1
  v_add_f32_dpp v44, v46, v44 row_shl:8 row_mask:0xf bank_mask:0x1
  v_add_f32_dpp v48, v50, v48 row_shl:8 row_mask:0xf bank_mask:0x1
  v_add_f32_dpp v20, v23, v20 row_shl:12 row_mask:0xf bank_mask:0x1
  v_add_f32_dpp v24, v27, v24 row_shl:12 row_mask:0xf bank_mask:0x1
  v_add_f32_dpp v28, v31, v28 row_shl:12 row_mask:0xf bank_mask:0x1
  v_add_f32_dpp v32, v35, v32 row_shl:12 row_mask:0xf bank_mask:0x1
  v_add_f32_dpp v36, v39, v36 row_shl:12 row_mask:0xf bank_mask:0x1
  v_add_f32_dpp v40, v43, v40 row_shl:12 row_mask:0xf bank_mask:0x1
  v_add_f32_dpp v44, v47, v44 row_shl:12 row_mask:0xf bank_mask:0x1
  v_add_f32_dpp v48, v51, v48 row_shl:12 row_mask:0xf bank_mask:0x1
  v_cvt_pk_bf16_f32 v21, v20, v24
  v_cvt_pk_bf16_f32 v29, v28, v32
  v_cvt_pk_bf16_f32 v37, v36, v40
  v_cvt_pk_bf16_f32 v45, v44, v48
  v_lshlrev_b32 v22, 16, v21
  v_and_b32 v23, 0xffff0000, v21
  v_lshlrev_b32 v30, 16, v29
  v_and_b32 v31, 0xffff0000, v29
  v_lshlrev_b32 v38, 16, v37
  v_and_b32 v39, 0xffff0000, v37
  v_lshlrev_b32 v46, 16, v45
  v_and_b32 v47, 0xffff0000, v45
  v_pk_mul_f32 v[22:23], v[22:23], s[68:69]
  v_pk_mul_f32 v[30:31], v[30:31], s[68:69]
  v_pk_mul_f32 v[38:39], v[38:39], s[68:69]
  v_pk_mul_f32 v[46:47], v[46:47], s[68:69]
  v_cvt_pk_bf16_f32 v21, v22, v23
  v_cvt_pk_bf16_f32 v29, v30, v31
  v_cvt_pk_bf16_f32 v37, v38, v39
  v_cvt_pk_bf16_f32 v45, v46, v47
  v_lshlrev_b32 v22, 16, v21
  v_and_b32 v23, 0xffff0000, v21
  v_lshlrev_b32 v30, 16, v29
  v_and_b32 v31, 0xffff0000, v29
  v_lshlrev_b32 v38, 16, v37
  v_and_b32 v39, 0xffff0000, v37
  v_lshlrev_b32 v46, 16, v45
  v_and_b32 v47, 0xffff0000, v45
  v_max3_f32 v9, v22, v23, v30
  v_max3_f32 v9, v9, v31, v38
  v_max3_f32 v9, v9, v39, v46
  v_max3_f32 v9, v9, v47, v8
  v_mov_b32 v10, v9
  s_nop 1
  v_permlane16_swap_b32 v9, v10
  v_max_f32 v9, v9, v10
  v_mov_b32 v10, v9
  s_nop 1
  v_permlane32_swap_b32 v9, v10
  v_max_f32 v9, v9, v10
  v_sub_f32 v10, v8, v9
  v_mul_f32 v14, s39, v9
  v_mul_f32 v10, s39, v10
  v_sub_f32 v14, 0, v14
  v_exp_f32 v10, v10
  v_mov_b32 v8, v9
  v_mov_b32 v15, v14
  v_pk_fma_f32 v[22:23], v[22:23], s[66:67], v[14:15]
  v_pk_fma_f32 v[30:31], v[30:31], s[66:67], v[14:15]
  v_pk_fma_f32 v[38:39], v[38:39], s[66:67], v[14:15]
  v_pk_fma_f32 v[46:47], v[46:47], s[66:67], v[14:15]
  v_mov_b32 v11, v10
  v_exp_f32 v22, v22
  v_exp_f32 v23, v23
  v_exp_f32 v30, v30
  v_exp_f32 v31, v31
  v_exp_f32 v38, v38
  v_exp_f32 v39, v39
  v_exp_f32 v46, v46
  v_exp_f32 v47, v47
  v_pk_fma_f32 v[12:13], v[12:13], v[10:11], v[22:23]
  v_cvt_pk_bf16_f32 v16, v22, v23
  v_cvt_pk_bf16_f32 v17, v30, v31
  v_cvt_pk_bf16_f32 v18, v38, v39
  v_cvt_pk_bf16_f32 v19, v46, v47
  v_pk_add_f32 v[12:13], v[12:13], v[30:31]
  v_pk_add_f32 v[12:13], v[12:13], v[38:39]
  v_pk_add_f32 v[12:13], v[12:13], v[46:47]
  v_pk_mul_f32 v[52:53], v[52:53], v[10:11]
  v_pk_mul_f32 v[54:55], v[54:55], v[10:11]
  v_pk_mul_f32 v[56:57], v[56:57], v[10:11]
  v_pk_mul_f32 v[58:59], v[58:59], v[10:11]
  v_pk_mul_f32 v[60:61], v[60:61], v[10:11]
  v_pk_mul_f32 v[62:63], v[62:63], v[10:11]
  v_pk_mul_f32 v[64:65], v[64:65], v[10:11]
  v_pk_mul_f32 v[66:67], v[66:67], v[10:11]
  v_pk_mul_f32 v[68:69], v[68:69], v[10:11]
  v_pk_mul_f32 v[70:71], v[70:71], v[10:11]
  v_pk_mul_f32 v[72:73], v[72:73], v[10:11]
  v_pk_mul_f32 v[74:75], v[74:75], v[10:11]
  v_pk_mul_f32 v[76:77], v[76:77], v[10:11]
  v_pk_mul_f32 v[78:79], v[78:79], v[10:11]
  v_pk_mul_f32 v[80:81], v[80:81], v[10:11]
  v_pk_mul_f32 v[82:83], v[82:83], v[10:11]
  v_perm_b32 v84, v104, v100, s40
  v_perm_b32 v85, v112, v108, s40
  v_perm_b32 v86, v120, v116, s40
  v_perm_b32 v87, v128, v124, s40
  s_nop 1
  v_mfma_f32_16x16x32_bf16 v[52:55], v[84:87], v[16:19], v[52:55]
  v_perm_b32 v88, v104, v100, s41
  v_perm_b32 v89, v112, v108, s41
  v_perm_b32 v90, v120, v116, s41
  v_perm_b32 v91, v128, v124, s41
  s_nop 1
  v_mfma_f32_16x16x32_bf16 v[56:59], v[88:91], v[16:19], v[56:59]
  v_perm_b32 v92, v105, v101, s40
  v_perm_b32 v93, v113, v109, s40
  v_perm_b32 v94, v121, v117, s40
  v_perm_b32 v95, v129, v125, s40
  s_nop 1
  v_mfma_f32_16x16x32_bf16 v[60:63], v[92:95], v[16:19], v[60:63]
  v_perm_b32 v96, v105, v101, s41
  v_perm_b32 v97, v113, v109, s41
  v_perm_b32 v98, v121, v117, s41
  v_perm_b32 v99, v129, v125, s41
  s_nop 1
  v_mfma_f32_16x16x32_bf16 v[64:67], v[96:99], v[16:19], v[64:67]
  v_perm_b32 v84, v106, v102, s40
  v_perm_b32 v85, v114, v110, s40
  v_perm_b32 v86, v122, v118, s40
  v_perm_b32 v87, v130, v126, s40
  s_nop 1
  v_mfma_f32_16x16x32_bf16 v[68:71], v[84:87], v[16:19], v[68:71]
  v_perm_b32 v88, v106, v102, s41
  v_perm_b32 v89, v114, v110, s41
  v_perm_b32 v90, v122, v118, s41
  v_perm_b32 v91, v130, v126, s41
  s_nop 1
  v_mfma_f32_16x16x32_bf16 v[72:75], v[88:91], v[16:19], v[72:75]
  v_perm_b32 v92, v107, v103, s40
  v_perm_b32 v93, v115, v111, s40
  v_perm_b32 v94, v123, v119, s40
  v_perm_b32 v95, v131, v127, s40
  s_nop 1
  v_mfma_f32_16x16x32_bf16 v[76:79], v[92:95], v[16:19], v[76:79]
  v_perm_b32 v96, v107, v103, s41
  v_perm_b32 v97, v115, v111, s41
  v_perm_b32 v98, v123, v119, s41
  v_perm_b32 v99, v131, v127, s41
  s_nop 1
  v_mfma_f32_16x16x32_bf16 v[80:83], v[96:99], v[16:19], v[80:83]
  s_add_u32 s47, s64, 96
  s_add_u32 s47, s47, s100
  s_and_b32 s47, s47, 511
  s_lshl_b32 s47, s47, 13
  s_add_u32 s36, s55, s47
  s_add_u32 s37, s36, 4096
  buffer_load_dwordx4 a[0:3], v2, s[28:31], s36 offen offset:0 nt
  buffer_load_dwordx4 a[4:7], v2, s[28:31], s36 offen offset:1024 nt
  buffer_load_dwordx4 a[8:11], v2, s[28:31], s36 offen offset:2048 nt
  buffer_load_dwordx4 a[12:15], v2, s[28:31], s36 offen offset:3072 nt
  buffer_load_dwordx4 a[16:19], v2, s[28:31], s37 offen offset:0 nt
  buffer_load_dwordx4 a[20:23], v2, s[28:31], s37 offen offset:1024 nt
  buffer_load_dwordx4 a[24:27], v2, s[28:31], s37 offen offset:2048 nt
  buffer_load_dwordx4 a[28:31], v2, s[28:31], s37 offen offset:3072 nt
  buffer_load_dwordx4 v[100:103], v3, s[32:35], s36 offen offset:0 nt
  buffer_load_dwordx4 v[104:107], v3, s[32:35], s36 offen offset:1024 nt
  buffer_load_dwordx4 v[108:111], v3, s[32:35], s36 offen offset:2048 nt
  buffer_load_dwordx4 v[112:115], v3, s[32:35], s36 offen offset:3072 nt
  buffer_load_dwordx4 v[116:119], v3, s[32:35], s37 offen offset:0 nt
  buffer_load_dwordx4 v[120:123], v3, s[32:35], s37 offen offset:1024 nt
  buffer_load_dwordx4 v[124:127], v3, s[32:35], s37 offen offset:2048 nt
  buffer_load_dwordx4 v[128:131], v3, s[32:35], s37 offen offset:3072 nt
  s_add_u32 s49, s49, 1
  v_mfma_f32_16x16x32_bf16 v[20:23], a[32:35], v[4:7], 0
  v_mfma_f32_16x16x32_bf16 v[24:27], a[36:39], v[4:7], 0
  v_mfma_f32_16x16x32_bf16 v[28:31], a[40:43], v[4:7], 0
  v_mfma_f32_16x16x32_bf16 v[32:35], a[44:47], v[4:7], 0
  v_mfma_f32_16x16x32_bf16 v[36:39], a[48:51], v[4:7], 0
  v_mfma_f32_16x16x32_bf16 v[40:43], a[52:55], v[4:7], 0
  v_mfma_f32_16x16x32_bf16 v[44:47], a[56:59], v[4:7], 0
  v_mfma_f32_16x16x32_bf16 v[48:51], a[60:63], v[4:7], 0
  s_nop 0
  v_add_f32_dpp v20, v21, v20 row_shl:4 row_mask:0xf bank_mask:0x1
  v_add_f32_dpp v24, v25, v24 row_shl:4 row_mask:0xf bank_mask:0x1
  v_add_f32_dpp v28, v29, v28 row_shl:4 row_mask:0xf bank_mask:0x1
  v_add_f32_dpp v32, v33, v32 row_shl:4 row_mask:0xf bank_mask:0x1
  v_add_f32_dpp v36, v37, v36 row_shl:4 row_mask:0xf bank_mask:0x1
  v_add_f32_dpp v40, v41, v40 row_shl:4 row_mask:0xf bank_mask:0x1
  v_add_f32_dpp v44, v45, v44 row_shl:4 row_mask:0xf bank_mask:0x1
  v_add_f32_dpp v48, v49, v48 row_shl:4 row_mask:0xf bank_mask:0x1
  v_add_f32_dpp v20, v22, v20 row_shl:8 row_mask:0xf bank_mask:0x1
  v_add_f32_dpp v24, v26, v24 row_shl:8 row_mask:0xf bank_mask:0x1
  v_add_f32_dpp v28, v30, v28 row_shl:8 row_mask:0xf bank_mask:0x1
  v_add_f32_dpp v32, v34, v32 row_shl:8 row_mask:0xf bank_mask:0x1
  v_add_f32_dpp v36, v38, v36 row_shl:8 row_mask:0xf bank_mask:0x1
  v_add_f32_dpp v40, v42, v40 row_shl:8 row_mask:0xf bank_mask:0x1
  v_add_f32_dpp v44, v46, v44 row_shl:8 row_mask:0xf bank_mask:0x1
  v_add_f32_dpp v48, v50, v48 row_shl:8 row_mask:0xf bank_mask:0x1
  v_add_f32_dpp v20, v23, v20 row_shl:12 row_mask:0xf bank_mask:0x1
  v_add_f32_dpp v24, v27, v24 row_shl:12 row_mask:0xf bank_mask:0x1
  v_add_f32_dpp v28, v31, v28 row_shl:12 row_mask:0xf bank_mask:0x1
  v_add_f32_dpp v32, v35, v32 row_shl:12 row_mask:0xf bank_mask:0x1
  v_add_f32_dpp v36, v39, v36 row_shl:12 row_mask:0xf bank_mask:0x1
  v_add_f32_dpp v40, v43, v40 row_shl:12 row_mask:0xf bank_mask:0x1
  v_add_f32_dpp v44, v47, v44 row_shl:12 row_mask:0xf bank_mask:0x1
  v_add_f32_dpp v48, v51, v48 row_shl:12 row_mask:0xf bank_mask:0x1
  v_cvt_pk_bf16_f32 v21, v20, v24
  v_cvt_pk_bf16_f32 v29, v28, v32
  v_cvt_pk_bf16_f32 v37, v36, v40
  v_cvt_pk_bf16_f32 v45, v44, v48
  v_lshlrev_b32 v22, 16, v21
  v_and_b32 v23, 0xffff0000, v21
  v_lshlrev_b32 v30, 16, v29
  v_and_b32 v31, 0xffff0000, v29
  v_lshlrev_b32 v38, 16, v37
  v_and_b32 v39, 0xffff0000, v37
  v_lshlrev_b32 v46, 16, v45
  v_and_b32 v47, 0xffff0000, v45
  v_pk_mul_f32 v[22:23], v[22:23], s[68:69]
  v_pk_mul_f32 v[30:31], v[30:31], s[68:69]
  v_pk_mul_f32 v[38:39], v[38:39], s[68:69]
  v_pk_mul_f32 v[46:47], v[46:47], s[68:69]
  v_cvt_pk_bf16_f32 v21, v22, v23
  v_cvt_pk_bf16_f32 v29, v30, v31
  v_cvt_pk_bf16_f32 v37, v38, v39
  v_cvt_pk_bf16_f32 v45, v46, v47
  v_lshlrev_b32 v22, 16, v21
  v_and_b32 v23, 0xffff0000, v21
  v_lshlrev_b32 v30, 16, v29
  v_and_b32 v31, 0xffff0000, v29
  v_lshlrev_b32 v38, 16, v37
  v_and_b32 v39, 0xffff0000, v37
  v_lshlrev_b32 v46, 16, v45
  v_and_b32 v47, 0xffff0000, v45
  v_max3_f32 v9, v22, v23, v30
  v_max3_f32 v9, v9, v31, v38
  v_max3_f32 v9, v9, v39, v46
  v_max3_f32 v9, v9, v47, v8
  v_mov_b32 v10, v9
  s_nop 1
  v_permlane16_swap_b32 v9, v10
  v_max_f32 v9, v9, v10
  v_mov_b32 v10, v9
  s_nop 1
  v_permlane32_swap_b32 v9, v10
  v_max_f32 v9, v9, v10
  v_sub_f32 v10, v8, v9
  v_mul_f32 v14, s39, v9
  v_mul_f32 v10, s39, v10
  v_sub_f32 v14, 0, v14
  v_exp_f32 v10, v10
  v_mov_b32 v8, v9
  v_mov_b32 v15, v14
  v_pk_fma_f32 v[22:23], v[22:23], s[66:67], v[14:15]
  v_pk_fma_f32 v[30:31], v[30:31], s[66:67], v[14:15]
  v_pk_fma_f32 v[38:39], v[38:39], s[66:67], v[14:15]
  v_pk_fma_f32 v[46:47], v[46:47], s[66:67], v[14:15]
  v_mov_b32 v11, v10
  v_exp_f32 v22, v22
  v_exp_f32 v23, v23
  v_exp_f32 v30, v30
  v_exp_f32 v31, v31
  v_exp_f32 v38, v38
  v_exp_f32 v39, v39
  v_exp_f32 v46, v46
  v_exp_f32 v47, v47
  v_pk_fma_f32 v[12:13], v[12:13], v[10:11], v[22:23]
  v_cvt_pk_bf16_f32 v16, v22, v23
  v_cvt_pk_bf16_f32 v17, v30, v31
  v_cvt_pk_bf16_f32 v18, v38, v39
  v_cvt_pk_bf16_f32 v19, v46, v47
  v_pk_add_f32 v[12:13], v[12:13], v[30:31]
  v_pk_add_f32 v[12:13], v[12:13], v[38:39]
  v_pk_add_f32 v[12:13], v[12:13], v[46:47]
  v_pk_mul_f32 v[52:53], v[52:53], v[10:11]
  v_pk_mul_f32 v[54:55], v[54:55], v[10:11]
  v_pk_mul_f32 v[56:57], v[56:57], v[10:11]
  v_pk_mul_f32 v[58:59], v[58:59], v[10:11]
  v_pk_mul_f32 v[60:61], v[60:61], v[10:11]
  v_pk_mul_f32 v[62:63], v[62:63], v[10:11]
  v_pk_mul_f32 v[64:65], v[64:65], v[10:11]
  v_pk_mul_f32 v[66:67], v[66:67], v[10:11]
  v_pk_mul_f32 v[68:69], v[68:69], v[10:11]
  v_pk_mul_f32 v[70:71], v[70:71], v[10:11]
  v_pk_mul_f32 v[72:73], v[72:73], v[10:11]
  v_pk_mul_f32 v[74:75], v[74:75], v[10:11]
  v_pk_mul_f32 v[76:77], v[76:77], v[10:11]
  v_pk_mul_f32 v[78:79], v[78:79], v[10:11]
  v_pk_mul_f32 v[80:81], v[80:81], v[10:11]
  v_pk_mul_f32 v[82:83], v[82:83], v[10:11]
  v_perm_b32 v84, v136, v132, s40
  v_perm_b32 v85, v144, v140, s40
  v_perm_b32 v86, v152, v148, s40
  v_perm_b32 v87, v160, v156, s40
  s_nop 1
  v_mfma_f32_16x16x32_bf16 v[52:55], v[84:87], v[16:19], v[52:55]
  v_perm_b32 v88, v136, v132, s41
  v_perm_b32 v89, v144, v140, s41
  v_perm_b32 v90, v152, v148, s41
  v_perm_b32 v91, v160, v156, s41
  s_nop 1
  v_mfma_f32_16x16x32_bf16 v[56:59], v[88:91], v[16:19], v[56:59]
  v_perm_b32 v92, v137, v133, s40
  v_perm_b32 v93, v145, v141, s40
  v_perm_b32 v94, v153, v149, s40
  v_perm_b32 v95, v161, v157, s40
  s_nop 1
  v_mfma_f32_16x16x32_bf16 v[60:63], v[92:95], v[16:19], v[60:63]
  v_perm_b32 v96, v137, v133, s41
  v_perm_b32 v97, v145, v141, s41
  v_perm_b32 v98, v153, v149, s41
  v_perm_b32 v99, v161, v157, s41
  s_nop 1
  v_mfma_f32_16x16x32_bf16 v[64:67], v[96:99], v[16:19], v[64:67]
  v_perm_b32 v84, v138, v134, s40
  v_perm_b32 v85, v146, v142, s40
  v_perm_b32 v86, v154, v150, s40
  v_perm_b32 v87, v162, v158, s40
  s_nop 1
  v_mfma_f32_16x16x32_bf16 v[68:71], v[84:87], v[16:19], v[68:71]
  v_perm_b32 v88, v138, v134, s41
  v_perm_b32 v89, v146, v142, s41
  v_perm_b32 v90, v154, v150, s41
  v_perm_b32 v91, v162, v158, s41
  s_nop 1
  v_mfma_f32_16x16x32_bf16 v[72:75], v[88:91], v[16:19], v[72:75]
  v_perm_b32 v92, v139, v135, s40
  v_perm_b32 v93, v147, v143, s40
  v_perm_b32 v94, v155, v151, s40
  v_perm_b32 v95, v163, v159, s40
  s_nop 1
  v_mfma_f32_16x16x32_bf16 v[76:79], v[92:95], v[16:19], v[76:79]
  v_perm_b32 v96, v139, v135, s41
  v_perm_b32 v97, v147, v143, s41
  v_perm_b32 v98, v155, v151, s41
  v_perm_b32 v99, v163, v159, s41
  s_nop 1
  v_mfma_f32_16x16x32_bf16 v[80:83], v[96:99], v[16:19], v[80:83]
  s_add_u32 s47, s64, 128
  s_add_u32 s47, s47, s100
  s_and_b32 s47, s47, 511
  s_lshl_b32 s47, s47, 13
  s_add_u32 s36, s55, s47
  s_add_u32 s37, s36, 4096
  buffer_load_dwordx4 a[32:35], v2, s[28:31], s36 offen offset:0 nt
  buffer_load_dwordx4 a[36:39], v2, s[28:31], s36 offen offset:1024 nt
  buffer_load_dwordx4 a[40:43], v2, s[28:31], s36 offen offset:2048 nt
  buffer_load_dwordx4 a[44:47], v2, s[28:31], s36 offen offset:3072 nt
  buffer_load_dwordx4 a[48:51], v2, s[28:31], s37 offen offset:0 nt
  buffer_load_dwordx4 a[52:55], v2, s[28:31], s37 offen offset:1024 nt
  buffer_load_dwordx4 a[56:59], v2, s[28:31], s37 offen offset:2048 nt
  buffer_load_dwordx4 a[60:63], v2, s[28:31], s37 offen offset:3072 nt
  buffer_load_dwordx4 v[132:135], v3, s[32:35], s36 offen offset:0 nt
  buffer_load_dwordx4 v[136:139], v3, s[32:35], s36 offen offset:1024 nt
  buffer_load_dwordx4 v[140:143], v3, s[32:35], s36 offen offset:2048 nt
  buffer_load_dwordx4 v[144:147], v3, s[32:35], s36 offen offset:3072 nt
  buffer_load_dwordx4 v[148:151], v3, s[32:35], s37 offen offset:0 nt
  buffer_load_dwordx4 v[152:155], v3, s[32:35], s37 offen offset:1024 nt
  buffer_load_dwordx4 v[156:159], v3, s[32:35], s37 offen offset:2048 nt
  buffer_load_dwordx4 v[160:163], v3, s[32:35], s37 offen offset:3072 nt
  s_add_u32 s49, s49, 1
  s_waitcnt vmcnt(40)
  v_mfma_f32_16x16x32_bf16 v[20:23], a[64:67], v[4:7], 0
  v_mfma_f32_16x16x32_bf16 v[24:27], a[68:71], v[4:7], 0
  v_mfma_f32_16x16x32_bf16 v[28:31], a[72:75], v[4:7], 0
  v_mfma_f32_16x16x32_bf16 v[32:35], a[76:79], v[4:7], 0
  v_mfma_f32_16x16x32_bf16 v[36:39], a[80:83], v[4:7], 0
  v_mfma_f32_16x16x32_bf16 v[40:43], a[84:87], v[4:7], 0
  v_mfma_f32_16x16x32_bf16 v[44:47], a[88:91], v[4:7], 0
  v_mfma_f32_16x16x32_bf16 v[48:51], a[92:95], v[4:7], 0
  s_nop 0
  v_add_f32_dpp v20, v21, v20 row_shl:4 row_mask:0xf bank_mask:0x1
  v_add_f32_dpp v24, v25, v24 row_shl:4 row_mask:0xf bank_mask:0x1
  v_add_f32_dpp v28, v29, v28 row_shl:4 row_mask:0xf bank_mask:0x1
  v_add_f32_dpp v32, v33, v32 row_shl:4 row_mask:0xf bank_mask:0x1
  v_add_f32_dpp v36, v37, v36 row_shl:4 row_mask:0xf bank_mask:0x1
  v_add_f32_dpp v40, v41, v40 row_shl:4 row_mask:0xf bank_mask:0x1
  v_add_f32_dpp v44, v45, v44 row_shl:4 row_mask:0xf bank_mask:0x1
  v_add_f32_dpp v48, v49, v48 row_shl:4 row_mask:0xf bank_mask:0x1
  v_add_f32_dpp v20, v22, v20 row_shl:8 row_mask:0xf bank_mask:0x1
  v_add_f32_dpp v24, v26, v24 row_shl:8 row_mask:0xf bank_mask:0x1
  v_add_f32_dpp v28, v30, v28 row_shl:8 row_mask:0xf bank_mask:0x1
  v_add_f32_dpp v32, v34, v32 row_shl:8 row_mask:0xf bank_mask:0x1
  v_add_f32_dpp v36, v38, v36 row_shl:8 row_mask:0xf bank_mask:0x1
  v_add_f32_dpp v40, v42, v40 row_shl:8 row_mask:0xf bank_mask:0x1
  v_add_f32_dpp v44, v46, v44 row_shl:8 row_mask:0xf bank_mask:0x1
  v_add_f32_dpp v48, v50, v48 row_shl:8 row_mask:0xf bank_mask:0x1
  v_add_f32_dpp v20, v23, v20 row_shl:12 row_mask:0xf bank_mask:0x1
  v_add_f32_dpp v24, v27, v24 row_shl:12 row_mask:0xf bank_mask:0x1
  v_add_f32_dpp v28, v31, v28 row_shl:12 row_mask:0xf bank_mask:0x1
  v_add_f32_dpp v32, v35, v32 row_shl:12 row_mask:0xf bank_mask:0x1
  v_add_f32_dpp v36, v39, v36 row_shl:12 row_mask:0xf bank_mask:0x1
  v_add_f32_dpp v40, v43, v40 row_shl:12 row_mask:0xf bank_mask:0x1
  v_add_f32_dpp v44, v47, v44 row_shl:12 row_mask:0xf bank_mask:0x1
  v_add_f32_dpp v48, v51, v48 row_shl:12 row_mask:0xf bank_mask:0x1
  v_cvt_pk_bf16_f32 v21, v20, v24
  v_cvt_pk_bf16_f32 v29, v28, v32
  v_cvt_pk_bf16_f32 v37, v36, v40
  v_cvt_pk_bf16_f32 v45, v44, v48
  v_lshlrev_b32 v22, 16, v21
  v_and_b32 v23, 0xffff0000, v21
  v_lshlrev_b32 v30, 16, v29
  v_and_b32 v31, 0xffff0000, v29
  v_lshlrev_b32 v38, 16, v37
  v_and_b32 v39, 0xffff0000, v37
  v_lshlrev_b32 v46, 16, v45
  v_and_b32 v47, 0xffff0000, v45
  v_pk_mul_f32 v[22:23], v[22:23], s[68:69]
  v_pk_mul_f32 v[30:31], v[30:31], s[68:69]
  v_pk_mul_f32 v[38:39], v[38:39], s[68:69]
  v_pk_mul_f32 v[46:47], v[46:47], s[68:69]
  v_cvt_pk_bf16_f32 v21, v22, v23
  v_cvt_pk_bf16_f32 v29, v30, v31
  v_cvt_pk_bf16_f32 v37, v38, v39
  v_cvt_pk_bf16_f32 v45, v46, v47
  v_lshlrev_b32 v22, 16, v21
  v_and_b32 v23, 0xffff0000, v21
  v_lshlrev_b32 v30, 16, v29
  v_and_b32 v31, 0xffff0000, v29
  v_lshlrev_b32 v38, 16, v37
  v_and_b32 v39, 0xffff0000, v37
  v_lshlrev_b32 v46, 16, v45
  v_and_b32 v47, 0xffff0000, v45
  v_max3_f32 v9, v22, v23, v30
  v_max3_f32 v9, v9, v31, v38
  v_max3_f32 v9, v9, v39, v46
  v_max3_f32 v9, v9, v47, v8
  v_mov_b32 v10, v9
  s_nop 1
  v_permlane16_swap_b32 v9, v10
  v_max_f32 v9, v9, v10
  v_mov_b32 v10, v9
  s_nop 1
  v_permlane32_swap_b32 v9, v10
  v_max_f32 v9, v9, v10
  v_sub_f32 v10, v8, v9
  v_mul_f32 v14, s39, v9
  v_mul_f32 v10, s39, v10
  v_sub_f32 v14, 0, v14
  v_exp_f32 v10, v10
  v_mov_b32 v8, v9
  v_mov_b32 v15, v14
  v_pk_fma_f32 v[22:23], v[22:23], s[66:67], v[14:15]
  v_pk_fma_f32 v[30:31], v[30:31], s[66:67], v[14:15]
  v_pk_fma_f32 v[38:39], v[38:39], s[66:67], v[14:15]
  v_pk_fma_f32 v[46:47], v[46:47], s[66:67], v[14:15]
  v_mov_b32 v11, v10
  v_exp_f32 v22, v22
  v_exp_f32 v23, v23
  v_exp_f32 v30, v30
  v_exp_f32 v31, v31
  v_exp_f32 v38, v38
  v_exp_f32 v39, v39
  v_exp_f32 v46, v46
  v_exp_f32 v47, v47
  v_pk_fma_f32 v[12:13], v[12:13], v[10:11], v[22:23]
  v_cvt_pk_bf16_f32 v16, v22, v23
  v_cvt_pk_bf16_f32 v17, v30, v31
  v_cvt_pk_bf16_f32 v18, v38, v39
  v_cvt_pk_bf16_f32 v19, v46, v47
  v_pk_add_f32 v[12:13], v[12:13], v[30:31]
  v_pk_add_f32 v[12:13], v[12:13], v[38:39]
  v_pk_add_f32 v[12:13], v[12:13], v[46:47]
  v_pk_mul_f32 v[52:53], v[52:53], v[10:11]
  v_pk_mul_f32 v[54:55], v[54:55], v[10:11]
  v_pk_mul_f32 v[56:57], v[56:57], v[10:11]
  v_pk_mul_f32 v[58:59], v[58:59], v[10:11]
  v_pk_mul_f32 v[60:61], v[60:61], v[10:11]
  v_pk_mul_f32 v[62:63], v[62:63], v[10:11]
  v_pk_mul_f32 v[64:65], v[64:65], v[10:11]
  v_pk_mul_f32 v[66:67], v[66:67], v[10:11]
  v_pk_mul_f32 v[68:69], v[68:69], v[10:11]
  v_pk_mul_f32 v[70:71], v[70:71], v[10:11]
  v_pk_mul_f32 v[72:73], v[72:73], v[10:11]
  v_pk_mul_f32 v[74:75], v[74:75], v[10:11]
  v_pk_mul_f32 v[76:77], v[76:77], v[10:11]
  v_pk_mul_f32 v[78:79], v[78:79], v[10:11]
  v_pk_mul_f32 v[80:81], v[80:81], v[10:11]
  v_pk_mul_f32 v[82:83], v[82:83], v[10:11]
  s_waitcnt vmcnt(32)
  v_perm_b32 v84, v168, v164, s40
  v_perm_b32 v85, v176, v172, s40
  v_perm_b32 v86, v184, v180, s40
  v_perm_b32 v87, v192, v188, s40
  s_nop 1
  v_mfma_f32_16x16x32_bf16 v[52:55], v[84:87], v[16:19], v[52:55]
  v_perm_b32 v88, v168, v164, s41
  v_perm_b32 v89, v176, v172, s41
  v_perm_b32 v90, v184, v180, s41
  v_perm_b32 v91, v192, v188, s41
  s_nop 1
  v_mfma_f32_16x16x32_bf16 v[56:59], v[88:91], v[16:19], v[56:59]
  v_perm_b32 v92, v169, v165, s40
  v_perm_b32 v93, v177, v173, s40
  v_perm_b32 v94, v185, v181, s40
  v_perm_b32 v95, v193, v189, s40
  s_nop 1
  v_mfma_f32_16x16x32_bf16 v[60:63], v[92:95], v[16:19], v[60:63]
  v_perm_b32 v96, v169, v165, s41
  v_perm_b32 v97, v177, v173, s41
  v_perm_b32 v98, v185, v181, s41
  v_perm_b32 v99, v193, v189, s41
  s_nop 1
  v_mfma_f32_16x16x32_bf16 v[64:67], v[96:99], v[16:19], v[64:67]
  v_perm_b32 v84, v170, v166, s40
  v_perm_b32 v85, v178, v174, s40
  v_perm_b32 v86, v186, v182, s40
  v_perm_b32 v87, v194, v190, s40
  s_nop 1
  v_mfma_f32_16x16x32_bf16 v[68:71], v[84:87], v[16:19], v[68:71]
  v_perm_b32 v88, v170, v166, s41
  v_perm_b32 v89, v178, v174, s41
  v_perm_b32 v90, v186, v182, s41
  v_perm_b32 v91, v194, v190, s41
  s_nop 1
  v_mfma_f32_16x16x32_bf16 v[72:75], v[88:91], v[16:19], v[72:75]
  v_perm_b32 v92, v171, v167, s40
  v_perm_b32 v93, v179, v175, s40
  v_perm_b32 v94, v187, v183, s40
  v_perm_b32 v95, v195, v191, s40
  s_nop 1
  v_mfma_f32_16x16x32_bf16 v[76:79], v[92:95], v[16:19], v[76:79]
  v_perm_b32 v96, v171, v167, s41
  v_perm_b32 v97, v179, v175, s41
  v_perm_b32 v98, v187, v183, s41
  v_perm_b32 v99, v195, v191, s41
  s_nop 1
  v_mfma_f32_16x16x32_bf16 v[80:83], v[96:99], v[16:19], v[80:83]
  s_add_u32 s49, s49, 1
  s_mov_b32 s101, 0
  s_mov_b32 s38, 2
  s_mov_b32 s56, 0
  s_mov_b32 s57, 0
  s_mov_b32 s58, 0
  s_mov_b32 s59, 0
L_loop:
  s_cmp_lg_u32 s70, 0
  s_cbranch_scc1 L_sw1L0
  s_waitcnt vmcnt(24)
L_sw1L0:
  s_cmp_eq_u32 s49, 3
  s_cbranch_scc1 L_hook4
  s_cmp_eq_u32 s49, 5
  s_cbranch_scc1 L_hook6
L_hook_ret:
  v_mfma_f32_16x16x32_bf16 v[20:23], a[0:3], v[4:7], 0
  v_mfma_f32_16x16x32_bf16 v[24:27], a[4:7], v[4:7], 0
  v_mfma_f32_16x16x32_bf16 v[28:31], a[8:11], v[4:7], 0
  v_mfma_f32_16x16x32_bf16 v[32:35], a[12:15], v[4:7], 0
  v_mfma_f32_16x16x32_bf16 v[36:39], a[16:19], v[4:7], 0
  v_mfma_f32_16x16x32_bf16 v[40:43], a[20:23], v[4:7], 0
  v_mfma_f32_16x16x32_bf16 v[44:47], a[24:27], v[4:7], 0
  v_mfma_f32_16x16x32_bf16 v[48:51], a[28:31], v[4:7], 0
  s_nop 0
  v_add_f32_dpp v20, v21, v20 row_shl:4 row_mask:0xf bank_mask:0x1
  v_add_f32_dpp v24, v25, v24 row_shl:4 row_mask:0xf bank_mask:0x1
  v_add_f32_dpp v28, v29, v28 row_shl:4 row_mask:0xf bank_mask:0x1
  v_add_f32_dpp v32, v33, v32 row_shl:4 row_mask:0xf bank_mask:0x1
  v_add_f32_dpp v36, v37, v36 row_shl:4 row_mask:0xf bank_mask:0x1
  v_add_f32_dpp v40, v41, v40 row_shl:4 row_mask:0xf bank_mask:0x1
  v_add_f32_dpp v44, v45, v44 row_shl:4 row_mask:0xf bank_mask:0x1
  v_add_f32_dpp v48, v49, v48 row_shl:4 row_mask:0xf bank_mask:0x1
  v_add_f32_dpp v20, v22, v20 row_shl:8 row_mask:0xf bank_mask:0x1
  v_add_f32_dpp v24, v26, v24 row_shl:8 row_mask:0xf bank_mask:0x1
  v_add_f32_dpp v28, v30, v28 row_shl:8 row_mask:0xf bank_mask:0x1
  v_add_f32_dpp v32, v34, v32 row_shl:8 row_mask:0xf bank_mask:0x1
  v_add_f32_dpp v36, v38, v36 row_shl:8 row_mask:0xf bank_mask:0x1
  v_add_f32_dpp v40, v42, v40 row_shl:8 row_mask:0xf bank_mask:0x1
  v_add_f32_dpp v44, v46, v44 row_shl:8 row_mask:0xf bank_mask:0x1
  v_add_f32_dpp v48, v50, v48 row_shl:8 row_mask:0xf bank_mask:0x1
  v_add_f32_dpp v20, v23, v20 row_shl:12 row_mask:0xf bank_mask:0x1
  v_add_f32_dpp v24, v27, v24 row_shl:12 row_mask:0xf bank_mask:0x1
  v_add_f32_dpp v28, v31, v28 row_shl:12 row_mask:0xf bank_mask:0x1
  v_add_f32_dpp v32, v35, v32 row_shl:12 row_mask:0xf bank_mask:0x1
  v_add_f32_dpp v36, v39, v36 row_shl:12 row_mask:0xf bank_mask:0x1
  v_add_f32_dpp v40, v43, v40 row_shl:12 row_mask:0xf bank_mask:0x1
  v_add_f32_dpp v44, v47, v44 row_shl:12 row_mask:0xf bank_mask:0x1
  v_add_f32_dpp v48, v51, v48 row_shl:12 row_mask:0xf bank_mask:0x1
  v_cvt_pk_bf16_f32 v21, v20, v24
  v_cvt_pk_bf16_f32 v29, v28, v32
  v_cvt_pk_bf16_f32 v37, v36, v40
  v_cvt_pk_bf16_f32 v45, v44, v48
  v_lshlrev_b32 v22, 16, v21
  v_and_b32 v23, 0xffff0000, v21
  v_lshlrev_b32 v30, 16, v29
  v_and_b32 v31, 0xffff0000, v29
  v_lshlrev_b32 v38, 16, v37
  v_and_b32 v39, 0xffff0000, v37
  v_lshlrev_b32 v46, 16, v45
  v_and_b32 v47, 0xffff0000, v45
  v_pk_mul_f32 v[22:23], v[22:23], s[68:69]
  v_pk_mul_f32 v[30:31], v[30:31], s[68:69]
  v_pk_mul_f32 v[38:39], v[38:39], s[68:69]
  v_pk_mul_f32 v[46:47], v[46:47], s[68:69]
  v_cvt_pk_bf16_f32 v21, v22, v23
  v_cvt_pk_bf16_f32 v29, v30, v31
  v_cvt_pk_bf16_f32 v37, v38, v39
  v_cvt_pk_bf16_f32 v45, v46, v47
  v_lshlrev_b32 v22, 16, v21
  v_and_b32 v23, 0xffff0000, v21
  v_lshlrev_b32 v30, 16, v29
  v_and_b32 v31, 0xffff0000, v29
  v_lshlrev_b32 v38, 16, v37
  v_and_b32 v39, 0xffff0000, v37
  v_lshlrev_b32 v46, 16, v45
  v_and_b32 v47, 0xffff0000, v45
  v_max3_f32 v9, v22, v23, v30
  v_max3_f32 v9, v9, v31, v38
  v_max3_f32 v9, v9, v39, v46
  v_max3_f32 v9, v9, v47, v8
  v_mov_b32 v10, v9
  s_nop 1
  v_permlane16_swap_b32 v9, v10
  v_max_f32 v9, v9, v10
  v_mov_b32 v10, v9
  s_nop 1
  v_permlane32_swap_b32 v9, v10
  v_max_f32 v9, v9, v10
  v_sub_f32 v10, v8, v9
  v_mul_f32 v14, s39, v9
  v_mul_f32 v10, s39, v10
  v_sub_f32 v14, 0, v14
  v_exp_f32 v10, v10
  v_mov_b32 v8, v9
  v_mov_b32 v15, v14
  v_pk_fma_f32 v[22:23], v[22:23], s[66:67], v[14:15]
  v_pk_fma_f32 v[30:31], v[30:31], s[66:67], v[14:15]
  v_pk_fma_f32 v[38:39], v[38:39], s[66:67], v[14:15]
  v_pk_fma_f32 v[46:47], v[46:47], s[66:67], v[14:15]
  v_mov_b32 v11, v10
  v_exp_f32 v22, v22
  v_exp_f32 v23, v23
  v_exp_f32 v30, v30
  v_exp_f32 v31, v31
  v_exp_f32 v38, v38
  v_exp_f32 v39, v39
  v_exp_f32 v46, v46
  v_exp_f32 v47, v47
  v_pk_fma_f32 v[12:13], v[12:13], v[10:11], v[22:23]
  v_cvt_pk_bf16_f32 v16, v22, v23
  v_cvt_pk_bf16_f32 v17, v30, v31
  v_cvt_pk_bf16_f32 v18, v38, v39
  v_cvt_pk_bf16_f32 v19, v46, v47
  v_pk_add_f32 v[12:13], v[12:13], v[30:31]
  v_pk_add_f32 v[12:13], v[12:13], v[38:39]
  v_pk_add_f32 v[12:13], v[12:13], v[46:47]
  v_pk_mul_f32 v[52:53], v[52:53], v[10:11]
  v_pk_mul_f32 v[54:55], v[54:55], v[10:11]
  v_pk_mul_f32 v[56:57], v[56:57], v[10:11]
  v_pk_mul_f32 v[58:59], v[58:59], v[10:11]
  v_pk_mul_f32 v[60:61], v[60:61], v[10:11]
  v_pk_mul_f32 v[62:63], v[62:63], v[10:11]
  v_pk_mul_f32 v[64:65], v[64:65], v[10:11]
  v_pk_mul_f32 v[66:67], v[66:67], v[10:11]
  v_pk_mul_f32 v[68:69], v[68:69], v[10:11]
  v_pk_mul_f32 v[70:71], v[70:71], v[10:11]
  v_pk_mul_f32 v[72:73], v[72:73], v[10:11]
  v_pk_mul_f32 v[74:75], v[74:75], v[10:11]
  v_pk_mul_f32 v[76:77], v[76:77], v[10:11]
  v_pk_mul_f32 v[78:79], v[78:79], v[10:11]
  v_pk_mul_f32 v[80:81], v[80:81], v[10:11]
  v_pk_mul_f32 v[82:83], v[82:83], v[10:11]
  s_cmp_lg_u32 s70, 0
  s_cbranch_scc1 L_sw2L0
  s_waitcnt vmcnt(16)
L_sw2L0:
  v_perm_b32 v84, v104, v100, s40
  v_perm_b32 v85, v112, v108, s40
  v_perm_b32 v86, v120, v116, s40
  v_perm_b32 v87, v128, v124, s40
  s_nop 1
  v_mfma_f32_16x16x32_bf16 v[52:55], v[84:87], v[16:19], v[52:55]
  v_perm_b32 v88, v104, v100, s41
  v_perm_b32 v89, v112, v108, s41
  v_perm_b32 v90, v120, v116, s41
  v_perm_b32 v91, v128, v124, s41
  s_nop 1
  v_mfma_f32_16x16x32_bf16 v[56:59], v[88:91], v[16:19], v[56:59]
  v_perm_b32 v92, v105, v101, s40
  v_perm_b32 v93, v113, v109, s40
  v_perm_b32 v94, v121, v117, s40
  v_perm_b32 v95, v129, v125, s40
  s_nop 1
  v_mfma_f32_16x16x32_bf16 v[60:63], v[92:95], v[16:19], v[60:63]
  v_perm_b32 v96, v105, v101, s41
  v_perm_b32 v97, v113, v109, s41
  v_perm_b32 v98, v121, v117, s41
  v_perm_b32 v99, v129, v125, s41
  s_nop 1
  v_mfma_f32_16x16x32_bf16 v[64:67], v[96:99], v[16:19], v[64:67]
  v_perm_b32 v84, v106, v102, s40
  v_perm_b32 v85, v114, v110, s40
  v_perm_b32 v86, v122, v118, s40
  v_perm_b32 v87, v130, v126, s40
  s_nop 1
  v_mfma_f32_16x16x32_bf16 v[68:71], v[84:87], v[16:19], v[68:71]
  v_perm_b32 v88, v106, v102, s41
  v_perm_b32 v89, v114, v110, s41
  v_perm_b32 v90, v122, v118, s41
  v_perm_b32 v91, v130, v126, s41
  s_nop 1
  v_mfma_f32_16x16x32_bf16 v[72:75], v[88:91], v[16:19], v[72:75]
  v_perm_b32 v92, v107, v103, s40
  v_perm_b32 v93, v115, v111, s40
  v_perm_b32 v94, v123, v119, s40
  v_perm_b32 v95, v131, v127, s40
  s_nop 1
  v_mfma_f32_16x16x32_bf16 v[76:79], v[92:95], v[16:19], v[76:79]
  v_perm_b32 v96, v107, v103, s41
  v_perm_b32 v97, v115, v111, s41
  v_perm_b32 v98, v123, v119, s41
  v_perm_b32 v99, v131, v127, s41
  s_nop 1
  v_mfma_f32_16x16x32_bf16 v[80:83], v[96:99], v[16:19], v[80:83]
  s_add_u32 s47, s49, 2
  s_cmp_lt_u32 s47, 12
  s_cbranch_scc0 L_dyn0
  s_lshl_b32 s47, s47, 5
  s_add_u32 s47, s47, s64
L_idx0:
  s_add_u32 s47, s47, s100
  s_and_b32 s47, s47, 511
  s_lshl_b32 s47, s47, 13
  s_add_u32 s36, s55, s47
  s_add_u32 s38, s38, 1
L_idxdone0:
  s_add_u32 s37, s36, 4096
L_idxdone2_0:
  s_cmp_lg_u32 s70, 0
  s_cbranch_scc1 L_skipld0
  buffer_load_dwordx4 a[0:3], v2, s[28:31], s36 offen offset:0 nt
  buffer_load_dwordx4 a[4:7], v2, s[28:31], s36 offen offset:1024 nt
  buffer_load_dwordx4 a[8:11], v2, s[28:31], s36 offen offset:2048 nt
  buffer_load_dwordx4 a[12:15], v2, s[28:31], s36 offen offset:3072 nt
  buffer_load_dwordx4 a[16:19], v2, s[28:31], s37 offen offset:0 nt
  buffer_load_dwordx4 a[20:23], v2, s[28:31], s37 offen offset:1024 nt
  buffer_load_dwordx4 a[24:27], v2, s[28:31], s37 offen offset:2048 nt
  buffer_load_dwordx4 a[28:31], v2, s[28:31], s37 offen offset:3072 nt
  buffer_load_dwordx4 v[100:103], v3, s[32:35], s36 offen offset:0 nt
  buffer_load_dwordx4 v[104:107], v3, s[32:35], s36 offen offset:1024 nt
  buffer_load_dwordx4 v[108:111], v3, s[32:35], s36 offen offset:2048 nt
  buffer_load_dwordx4 v[112:115], v3, s[32:35], s36 offen offset:3072 nt
  buffer_load_dwordx4 v[116:119], v3, s[32:35], s37 offen offset:0 nt
  buffer_load_dwordx4 v[120:123], v3, s[32:35], s37 offen offset:1024 nt
  buffer_load_dwordx4 v[124:127], v3, s[32:35], s37 offen offset:2048 nt
  buffer_load_dwordx4 v[128:131], v3, s[32:35], s37 offen offset:3072 nt
L_skipld0:
  s_add_u32 s49, s49, 1
  s_sub_u32 s38, s38, 1
  s_cmp_eq_u32 s38, 0
  s_cbranch_scc1 L_fin
  s_cmp_lg_u32 s70, 0
  s_cbranch_scc1 L_sw1L1
  s_waitcnt vmcnt(24)
L_sw1L1:
  v_mfma_f32_16x16x32_bf16 v[20:23], a[32:35], v[4:7], 0
  v_mfma_f32_16x16x32_bf16 v[24:27], a[36:39], v[4:7], 0
  v_mfma_f32_16x16x32_bf16 v[28:31], a[40:43], v[4:7], 0
  v_mfma_f32_16x16x32_bf16 v[32:35], a[44:47], v[4:7], 0
  v_mfma_f32_16x16x32_bf16 v[36:39], a[48:51], v[4:7], 0
  v_mfma_f32_16x16x32_bf16 v[40:43], a[52:55], v[4:7], 0
  v_mfma_f32_16x16x32_bf16 v[44:47], a[56:59], v[4:7], 0
  v_mfma_f32_16x16x32_bf16 v[48:51], a[60:63], v[4:7], 0
  s_nop 0
  v_add_f32_dpp v20, v21, v20 row_shl:4 row_mask:0xf bank_mask:0x1
  v_add_f32_dpp v24, v25, v24 row_shl:4 row_mask:0xf bank_mask:0x1
  v_add_f32_dpp v28, v29, v28 row_shl:4 row_mask:0xf bank_mask:0x1
  v_add_f32_dpp v32, v33, v32 row_shl:4 row_mask:0xf bank_mask:0x1
  v_add_f32_dpp v36, v37, v36 row_shl:4 row_mask:0xf bank_mask:0x1
  v_add_f32_dpp v40, v41, v40 row_shl:4 row_mask:0xf bank_mask:0x1
  v_add_f32_dpp v44, v45, v44 row_shl:4 row_mask:0xf bank_mask:0x1
  v_add_f32_dpp v48, v49, v48 row_shl:4 row_mask:0xf bank_mask:0x1
  v_add_f32_dpp v20, v22, v20 row_shl:8 row_mask:0xf bank_mask:0x1
  v_add_f32_dpp v24, v26, v24 row_shl:8 row_mask:0xf bank_mask:0x1
  v_add_f32_dpp v28, v30, v28 row_shl:8 row_mask:0xf bank_mask:0x1
  v_add_f32_dpp v32, v34, v32 row_shl:8 row_mask:0xf bank_mask:0x1
  v_add_f32_dpp v36, v38, v36 row_shl:8 row_mask:0xf bank_mask:0x1
  v_add_f32_dpp v40, v42, v40 row_shl:8 row_mask:0xf bank_mask:0x1
  v_add_f32_dpp v44, v46, v44 row_shl:8 row_mask:0xf bank_mask:0x1
  v_add_f32_dpp v48, v50, v48 row_shl:8 row_mask:0xf bank_mask:0x1
  v_add_f32_dpp v20, v23, v20 row_shl:12 row_mask:0xf bank_mask:0x1
  v_add_f32_dpp v24, v27, v24 row_shl:12 row_mask:0xf bank_mask:0x1
  v_add_f32_dpp v28, v31, v28 row_shl:12 row_mask:0xf bank_mask:0x1
  v_add_f32_dpp v32, v35, v32 row_shl:12 row_mask:0xf bank_mask:0x1
  v_add_f32_dpp v36, v39, v36 row_shl:12 row_mask:0xf bank_mask:0x1
  v_add_f32_dpp v40, v43, v40 row_shl:12 row_mask:0xf bank_mask:0x1
  v_add_f32_dpp v44, v47, v44 row_shl:12 row_mask:0xf bank_mask:0x1
  v_add_f32_dpp v48, v51, v48 row_shl:12 row_mask:0xf bank_mask:0x1
  v_cvt_pk_bf16_f32 v21, v20, v24
  v_cvt_pk_bf16_f32 v29, v28, v32
  v_cvt_pk_bf16_f32 v37, v36, v40
  v_cvt_pk_bf16_f32 v45, v44, v48
  v_lshlrev_b32 v22, 16, v21
  v_and_b32 v23, 0xffff0000, v21
  v_lshlrev_b32 v30, 16, v29
  v_and_b32 v31, 0xffff0000, v29
  v_lshlrev_b32 v38, 16, v37
  v_and_b32 v39, 0xffff0000, v37
  v_lshlrev_b32 v46, 16, v45
  v_and_b32 v47, 0xffff0000, v45
  v_pk_mul_f32 v[22:23], v[22:23], s[68:69]
  v_pk_mul_f32 v[30:31], v[30:31], s[68:69]
  v_pk_mul_f32 v[38:39], v[38:39], s[68:69]
  v_pk_mul_f32 v[46:47], v[46:47], s[68:69]
  v_cvt_pk_bf16_f32 v21, v22, v23
  v_cvt_pk_bf16_f32 v29, v30, v31
  v_cvt_pk_bf16_f32 v37, v38, v39
  v_cvt_pk_bf16_f32 v45, v46, v47
  v_lshlrev_b32 v22, 16, v21
  v_and_b32 v23, 0xffff0000, v21
  v_lshlrev_b32 v30, 16, v29
  v_and_b32 v31, 0xffff0000, v29
  v_lshlrev_b32 v38, 16, v37
  v_and_b32 v39, 0xffff0000, v37
  v_lshlrev_b32 v46, 16, v45
  v_and_b32 v47, 0xffff0000, v45
  v_max3_f32 v9, v22, v23, v30
  v_max3_f32 v9, v9, v31, v38
  v_max3_f32 v9, v9, v39, v46
  v_max3_f32 v9, v9, v47, v8
  v_mov_b32 v10, v9
  s_nop 1
  v_permlane16_swap_b32 v9, v10
  v_max_f32 v9, v9, v10
  v_mov_b32 v10, v9
  s_nop 1
  v_permlane32_swap_b32 v9, v10
  v_max_f32 v9, v9, v10
  v_sub_f32 v10, v8, v9
  v_mul_f32 v14, s39, v9
  v_mul_f32 v10, s39, v10
  v_sub_f32 v14, 0, v14
  v_exp_f32 v10, v10
  v_mov_b32 v8, v9
  v_mov_b32 v15, v14
  v_pk_fma_f32 v[22:23], v[22:23], s[66:67], v[14:15]
  v_pk_fma_f32 v[30:31], v[30:31], s[66:67], v[14:15]
  v_pk_fma_f32 v[38:39], v[38:39], s[66:67], v[14:15]
  v_pk_fma_f32 v[46:47], v[46:47], s[66:67], v[14:15]
  v_mov_b32 v11, v10
  v_exp_f32 v22, v22
  v_exp_f32 v23, v23
  v_exp_f32 v30, v30
  v_exp_f32 v31, v31
  v_exp_f32 v38, v38
  v_exp_f32 v39, v39
  v_exp_f32 v46, v46
  v_exp_f32 v47, v47
  v_pk_fma_f32 v[12:13], v[12:13], v[10:11], v[22:23]
  v_cvt_pk_bf16_f32 v16, v22, v23
  v_cvt_pk_bf16_f32 v17, v30, v31
  v_cvt_pk_bf16_f32 v18, v38, v39
  v_cvt_pk_bf16_f32 v19, v46, v47
  v_pk_add_f32 v[12:13], v[12:13], v[30:31]
  v_pk_add_f32 v[12:13], v[12:13], v[38:39]
  v_pk_add_f32 v[12:13], v[12:13], v[46:47]
  v_pk_mul_f32 v[52:53], v[52:53], v[10:11]
  v_pk_mul_f32 v[54:55], v[54:55], v[10:11]
  v_pk_mul_f32 v[56:57], v[56:57], v[10:11]
  v_pk_mul_f32 v[58:59], v[58:59], v[10:11]
  v_pk_mul_f32 v[60:61], v[60:61], v[10:11]
  v_pk_mul_f32 v[62:63], v[62:63], v[10:11]
  v_pk_mul_f32 v[64:65], v[64:65], v[10:11]
  v_pk_mul_f32 v[66:67], v[66:67], v[10:11]
  v_pk_mul_f32 v[68:69], v[68:69], v[10:11]
  v_pk_mul_f32 v[70:71], v[70:71], v[10:11]
  v_pk_mul_f32 v[72:73], v[72:73], v[10:11]
  v_pk_mul_f32 v[74:75], v[74:75], v[10:11]
  v_pk_mul_f32 v[76:77], v[76:77], v[10:11]
  v_pk_mul_f32 v[78:79], v[78:79], v[10:11]
  v_pk_mul_f32 v[80:81], v[80:81], v[10:11]
  v_pk_mul_f32 v[82:83], v[82:83], v[10:11]
  s_cmp_lg_u32 s70, 0
  s_cbranch_scc1 L_sw2L1
  s_waitcnt vmcnt(16)
L_sw2L1:
  v_perm_b32 v84, v136, v132, s40
  v_perm_b32 v85, v144, v140, s40
  v_perm_b32 v86, v152, v148, s40
  v_perm_b32 v87, v160, v156, s40
  s_nop 1
  v_mfma_f32_16x16x32_bf16 v[52:55], v[84:87], v[16:19], v[52:55]
  v_perm_b32 v88, v136, v132, s41
  v_perm_b32 v89, v144, v140, s41
  v_perm_b32 v90, v152, v148, s41
  v_perm_b32 v91, v160, v156, s41
  s_nop 1
  v_mfma_f32_16x16x32_bf16 v[56:59], v[88:91], v[16:19], v[56:59]
  v_perm_b32 v92, v137, v133, s40
  v_perm_b32 v93, v145, v141, s40
  v_perm_b32 v94, v153, v149, s40
  v_perm_b32 v95, v161, v157, s40
  s_nop 1
  v_mfma_f32_16x16x32_bf16 v[60:63], v[92:95], v[16:19], v[60:63]
  v_perm_b32 v96, v137, v133, s41
  v_perm_b32 v97, v145, v141, s41
  v_perm_b32 v98, v153, v149, s41
  v_perm_b32 v99, v161, v157, s41
  s_nop 1
  v_mfma_f32_16x16x32_bf16 v[64:67], v[96:99], v[16:19], v[64:67]
  v_perm_b32 v84, v138, v134, s40
  v_perm_b32 v85, v146, v142, s40
  v_perm_b32 v86, v154, v150, s40
  v_perm_b32 v87, v162, v158, s40
  s_nop 1
  v_mfma_f32_16x16x32_bf16 v[68:71], v[84:87], v[16:19], v[68:71]
  v_perm_b32 v88, v138, v134, s41
  v_perm_b32 v89, v146, v142, s41
  v_perm_b32 v90, v154, v150, s41
  v_perm_b32 v91, v162, v158, s41
  s_nop 1
  v_mfma_f32_16x16x32_bf16 v[72:75], v[88:91], v[16:19], v[72:75]
  v_perm_b32 v92, v139, v135, s40
  v_perm_b32 v93, v147, v143, s40
  v_perm_b32 v94, v155, v151, s40
  v_perm_b32 v95, v163, v159, s40
  s_nop 1
  v_mfma_f32_16x16x32_bf16 v[76:79], v[92:95], v[16:19], v[76:79]
  v_perm_b32 v96, v139, v135, s41
  v_perm_b32 v97, v147, v143, s41
  v_perm_b32 v98, v155, v151, s41
  v_perm_b32 v99, v163, v159, s41
  s_nop 1
  v_mfma_f32_16x16x32_bf16 v[80:83], v[96:99], v[16:19], v[80:83]
  s_add_u32 s47, s49, 2
  s_cmp_lt_u32 s47, 12
  s_cbranch_scc0 L_dyn1
  s_lshl_b32 s47, s47, 5
  s_add_u32 s47, s47, s64
L_idx1:
  s_add_u32 s47, s47, s100
  s_and_b32 s47, s47, 511
  s_lshl_b32 s47, s47, 13
  s_add_u32 s36, s55, s47
  s_add_u32 s38, s38, 1
L_idxdone1:
  s_add_u32 s37, s36, 4096
L_idxdone2_1:
  s_cmp_lg_u32 s70, 0
  s_cbranch_scc1 L_skipld1
  buffer_load_dwordx4 a[32:35], v2, s[28:31], s36 offen offset:0 nt
  buffer_load_dwordx4 a[36:39], v2, s[28:31], s36 offen offset:1024 nt
  buffer_load_dwordx4 a[40:43], v2, s[28:31], s36 offen offset:2048 nt
  buffer_load_dwordx4 a[44:47], v2, s[28:31], s36 offen offset:3072 nt
  buffer_load_dwordx4 a[48:51], v2, s[28:31], s37 offen offset:0 nt
  buffer_load_dwordx4 a[52:55], v2, s[28:31], s37 offen offset:1024 nt
  buffer_load_dwordx4 a[56:59], v2, s[28:31], s37 offen offset:2048 nt
  buffer_load_dwordx4 a[60:63], v2, s[28:31], s37 offen offset:3072 nt
  buffer_load_dwordx4 v[132:135], v3, s[32:35], s36 offen offset:0 nt
  buffer_load_dwordx4 v[136:139], v3, s[32:35], s36 offen offset:1024 nt
  buffer_load_dwordx4 v[140:143], v3, s[32:35], s36 offen offset:2048 nt
  buffer_load_dwordx4 v[144:147], v3, s[32:35], s36 offen offset:3072 nt
  buffer_load_dwordx4 v[148:151], v3, s[32:35], s37 offen offset:0 nt
  buffer_load_dwordx4 v[152:155], v3, s[32:35], s37 offen offset:1024 nt
  buffer_load_dwordx4 v[156:159], v3, s[32:35], s37 offen offset:2048 nt
  buffer_load_dwordx4 v[160:163], v3, s[32:35], s37 offen offset:3072 nt
L_skipld1:
  s_add_u32 s49, s49, 1
  s_sub_u32 s38, s38, 1
  s_cmp_eq_u32 s38, 0
  s_cbranch_scc1 L_fin
  s_branch L_loop
L_dyn0:
  s_cmp_lg_u32 s70, 0
  s_cbranch_scc1 L_oob0
  s_cmp_eq_u32 s53, 2
  s_cbranch_scc0 L_nq0
  s_cmp_ge_u32 s101, 88
  s_cbranch_scc1 L_exh0
L_nq0:
  s_cmp_eq_u32 s53, 1
  s_cbranch_scc0 L_nqb0
  s_cmp_ge_u32 s101, 104
  s_cbranch_scc1 L_exh0
L_nqb0:
  s_mov_b64 exec, 1
  global_atomic_add v247, v248, v249, s[26:27] sc0
  s_mov_b64 exec, -1
  s_waitcnt vmcnt(0)
  v_readfirstlane_b32 s47, v247
  s_nop 0
  s_mov_b32 s101, s47
  s_add_u32 s47, s47, 384
  s_cmp_lt_u32 s47, 512
  s_cbranch_scc1 L_idx0
L_exh0:
  s_mov_b32 s70, 1
  s_waitcnt vmcnt(0)
  s_cmp_eq_u32 s53, 1
  s_cbranch_scc0 L_oob0
  s_mov_b32 s63, 0
  s_branch L_bw
L_bwret0:
L_oob0:
  s_mov_b32 s36, 0x7ff00000
  s_branch L_idxdone0
L_dyn1:
  s_cmp_lg_u32 s70, 0
  s_cbranch_scc1 L_oob1
  s_cmp_eq_u32 s53, 2
  s_cbranch_scc0 L_nq1
  s_cmp_ge_u32 s101, 88
  s_cbranch_scc1 L_exh1
L_nq1:
  s_cmp_eq_u32 s53, 1
  s_cbranch_scc0 L_nqb1
  s_cmp_ge_u32 s101, 104
  s_cbranch_scc1 L_exh1
L_nqb1:
  s_mov_b64 exec, 1
  global_atomic_add v247, v248, v249, s[26:27] sc0
  s_mov_b64 exec, -1
  s_waitcnt vmcnt(0)
  v_readfirstlane_b32 s47, v247
  s_nop 0
  s_mov_b32 s101, s47
  s_add_u32 s47, s47, 384
  s_cmp_lt_u32 s47, 512
  s_cbranch_scc1 L_idx1
L_exh1:
  s_mov_b32 s70, 1
  s_waitcnt vmcnt(0)
  s_cmp_eq_u32 s53, 1
  s_cbranch_scc0 L_oob1
  s_mov_b32 s63, 1
  s_branch L_bw
L_bwret1:
L_oob1:
  s_mov_b32 s36, 0x7ff00000
  s_branch L_idxdone1
L_bw:
  v_and_b32 v9, 15, v1
  v_lshrrev_b32 v10, 4, v1
  v_lshlrev_b32 v11, 11, v10
  v_lshl_add_u32 v11, v9, 3, v11
  s_lshr_b32 s48, s54, 3
  s_lshl_b32 s48, s48, 19
  s_lshl_b32 s47, s3, 17
  s_add_u32 s48, s48, s47
  s_and_b32 s47, s54, 7
  s_lshl_b32 s47, s47, 7
  s_add_u32 s48, s48, s47
  v_add_u32 v11, s48, v11
  s_mov_b32 s56, s12
  s_mov_b32 s57, s13
  s_mov_b32 s58, 0x400000
  s_mov_b32 s59, 0x20000
  s_mov_b32 s48, 0
  buffer_load_dwordx2 v[164:165], v11, s[56:59], s48 offen nt
  s_mov_b32 s48, 8192
  buffer_load_dwordx2 v[166:167], v11, s[56:59], s48 offen nt
  s_mov_b32 s48, 16384
  buffer_load_dwordx2 v[168:169], v11, s[56:59], s48 offen nt
  s_mov_b32 s48, 24576
  buffer_load_dwordx2 v[170:171], v11, s[56:59], s48 offen nt
  s_mov_b32 s48, 1024
  buffer_load_dwordx2 v[172:173], v11, s[56:59], s48 offen nt
  s_mov_b32 s48, 9216
  buffer_load_dwordx2 v[174:175], v11, s[56:59], s48 offen nt
  s_mov_b32 s48, 17408
  buffer_load_dwordx2 v[176:177], v11, s[56:59], s48 offen nt
  s_mov_b32 s48, 25600
  buffer_load_dwordx2 v[178:179], v11, s[56:59], s48 offen nt
  s_mov_b32 s48, 32768
  buffer_load_dwordx2 v[180:181], v11, s[56:59], s48 offen nt
  s_mov_b32 s48, 40960
  buffer_load_dwordx2 v[182:183], v11, s[56:59], s48 offen nt
  s_mov_b32 s48, 49152
  buffer_load_dwordx2 v[184:185], v11, s[56:59], s48 offen nt
  s_mov_b32 s48, 57344
  buffer_load_dwordx2 v[186:187], v11, s[56:59], s48 offen nt
  s_mov_b32 s48, 33792
  buffer_load_dwordx2 v[188:189], v11, s[56:59], s48 offen nt
  s_mov_b32 s48, 41984
  buffer_load_dwordx2 v[190:191], v11, s[56:59], s48 offen nt
  s_mov_b32 s48, 50176
  buffer_load_dwordx2 v[192:193], v11, s[56:59], s48 offen nt
  s_mov_b32 s48, 58368
  buffer_load_dwordx2 v[194:195], v11, s[56:59], s48 offen nt
  s_mov_b32 s48, 65536
  buffer_load_dwordx2 v[196:197], v11, s[56:59], s48 offen nt
  s_mov_b32 s48, 73728
  buffer_load_dwordx2 v[198:199], v11, s[56:59], s48 offen nt
  s_mov_b32 s48, 81920
  buffer_load_dwordx2 v[200:201], v11, s[56:59], s48 offen nt
  s_mov_b32 s48, 90112
  buffer_load_dwordx2 v[202:203], v11, s[56:59], s48 offen nt
  s_mov_b32 s48, 66560
  buffer_load_dwordx2 v[204:205], v11, s[56:59], s48 offen nt
  s_mov_b32 s48, 74752
  buffer_load_dwordx2 v[206:207], v11, s[56:59], s48 offen nt
  s_mov_b32 s48, 82944
  buffer_load_dwordx2 v[208:209], v11, s[56:59], s48 offen nt
  s_mov_b32 s48, 91136
  buffer_load_dwordx2 v[210:211], v11, s[56:59], s48 offen nt
  s_mov_b32 s48, 98304
  buffer_load_dwordx2 v[212:213], v11, s[56:59], s48 offen nt
  s_mov_b32 s48, 106496
  buffer_load_dwordx2 v[214:215], v11, s[56:59], s48 offen nt
  s_mov_b32 s48, 114688
  buffer_load_dwordx2 v[216:217], v11, s[56:59], s48 offen nt
  s_mov_b32 s48, 122880
  buffer_load_dwordx2 v[218:219], v11, s[56:59], s48 offen nt
  s_mov_b32 s48, 99328
  buffer_load_dwordx2 v[220:221], v11, s[56:59], s48 offen nt
  s_mov_b32 s48, 107520
  buffer_load_dwordx2 v[222:223], v11, s[56:59], s48 offen nt
  s_mov_b32 s48, 115712
  buffer_load_dwordx2 v[224:225], v11, s[56:59], s48 offen nt
  s_mov_b32 s48, 123904
  buffer_load_dwordx2 v[226:227], v11, s[56:59], s48 offen nt
  s_cmp_eq_u32 s63, 0
  s_cbranch_scc1 L_bwret0
  s_branch L_bwret1
L_hook6:
  s_mov_b32 s65, 262144
L_cchk:
  v_readfirstlane_b32 s47, v250
  s_nop 0
  s_cmp_ge_u32 s47, 256
  s_cbranch_scc1 L_hook_ret
  s_sub_u32 s65, s65, 1
  s_cmp_eq_u32 s65, 0
  s_cbranch_scc1 L_hook_ret
  v_mov_b32 v9, 0
  global_load_dword v250, v9, s[24:25] sc1
  s_waitcnt vmcnt(0)
  s_branch L_cchk
L_hook4:
  v_mov_b32 v9, 0
  global_load_dword v250, v9, s[24:25] sc1
  s_branch L_wp1
  s_cmp_eq_u32 s53, 1
  s_cbranch_scc0 L_wp1
  v_accvgpr_read_b32 v20, a96
  v_accvgpr_read_b32 v21, a97
  v_accvgpr_read_b32 v22, a98
  v_accvgpr_read_b32 v23, a99
  v_accvgpr_read_b32 v24, a100
  v_accvgpr_read_b32 v25, a101
  v_accvgpr_read_b32 v26, a102
  v_accvgpr_read_b32 v27, a103
  v_accvgpr_read_b32 v28, a104
  v_accvgpr_read_b32 v29, a105
  v_accvgpr_read_b32 v30, a106
  v_accvgpr_read_b32 v31, a107
  v_accvgpr_read_b32 v32, a108
  v_accvgpr_read_b32 v33, a109
  v_accvgpr_read_b32 v34, a110
  v_accvgpr_read_b32 v35, a111
  v_perm_b32 v36, v22, v20, s40
  v_perm_b32 v37, v26, v24, s40
  v_perm_b32 v38, v30, v28, s40
  v_perm_b32 v39, v34, v32, s40
  v_perm_b32 v40, v22, v20, s41
  v_perm_b32 v41, v26, v24, s41
  v_perm_b32 v42, v30, v28, s41
  v_perm_b32 v43, v34, v32, s41
  v_perm_b32 v44, v23, v21, s40
  v_perm_b32 v45, v27, v25, s40
  v_perm_b32 v46, v31, v29, s40
  v_perm_b32 v47, v35, v33, s40
  v_perm_b32 v48, v23, v21, s41
  v_perm_b32 v49, v27, v25, s41
  v_perm_b32 v50, v31, v29, s41
  v_perm_b32 v51, v35, v33, s41
  v_accvgpr_write_b32 a96, v36
  v_accvgpr_write_b32 a97, v37
  v_accvgpr_write_b32 a98, v38
  v_accvgpr_write_b32 a99, v39
  v_accvgpr_write_b32 a100, v40
  v_accvgpr_write_b32 a101, v41
  v_accvgpr_write_b32 a102, v42
  v_accvgpr_write_b32 a103, v43
  v_accvgpr_write_b32 a104, v44
  v_accvgpr_write_b32 a105, v45
  v_accvgpr_write_b32 a106, v46
  v_accvgpr_write_b32 a107, v47
  v_accvgpr_write_b32 a108, v48
  v_accvgpr_write_b32 a109, v49
  v_accvgpr_write_b32 a110, v50
  v_accvgpr_write_b32 a111, v51
  v_accvgpr_read_b32 v20, a112
  v_accvgpr_read_b32 v21, a113
  v_accvgpr_read_b32 v22, a114
  v_accvgpr_read_b32 v23, a115
  v_accvgpr_read_b32 v24, a116
  v_accvgpr_read_b32 v25, a117
  v_accvgpr_read_b32 v26, a118
  v_accvgpr_read_b32 v27, a119
  v_accvgpr_read_b32 v28, a120
  v_accvgpr_read_b32 v29, a121
  v_accvgpr_read_b32 v30, a122
  v_accvgpr_read_b32 v31, a123
  v_accvgpr_read_b32 v32, a124
  v_accvgpr_read_b32 v33, a125
  v_accvgpr_read_b32 v34, a126
  v_accvgpr_read_b32 v35, a127
  v_perm_b32 v36, v22, v20, s40
  v_perm_b32 v37, v26, v24, s40
  v_perm_b32 v38, v30, v28, s40
  v_perm_b32 v39, v34, v32, s40
  v_perm_b32 v40, v22, v20, s41
  v_perm_b32 v41, v26, v24, s41
  v_perm_b32 v42, v30, v28, s41
  v_perm_b32 v43, v34, v32, s41
  v_perm_b32 v44, v23, v21, s40
  v_perm_b32 v45, v27, v25, s40
  v_perm_b32 v46, v31, v29, s40
  v_perm_b32 v47, v35, v33, s40
  v_perm_b32 v48, v23, v21, s41
  v_perm_b32 v49, v27, v25, s41
  v_perm_b32 v50, v31, v29, s41
  v_perm_b32 v51, v35, v33, s41
  v_accvgpr_write_b32 a112, v36
  v_accvgpr_write_b32 a113, v37
  v_accvgpr_write_b32 a114, v38
  v_accvgpr_write_b32 a115, v39
  v_accvgpr_write_b32 a116, v40
  v_accvgpr_write_b32 a117, v41
  v_accvgpr_write_b32 a118, v42
  v_accvgpr_write_b32 a119, v43
  v_accvgpr_write_b32 a120, v44
  v_accvgpr_write_b32 a121, v45
  v_accvgpr_write_b32 a122, v46
  v_accvgpr_write_b32 a123, v47
  v_accvgpr_write_b32 a124, v48
  v_accvgpr_write_b32 a125, v49
  v_accvgpr_write_b32 a126, v50
  v_accvgpr_write_b32 a127, v51
  v_accvgpr_read_b32 v20, a128
  v_accvgpr_read_b32 v21, a129
  v_accvgpr_read_b32 v22, a130
  v_accvgpr_read_b32 v23, a131
  v_accvgpr_read_b32 v24, a132
  v_accvgpr_read_b32 v25, a133
  v_accvgpr_read_b32 v26, a134
  v_accvgpr_read_b32 v27, a135
  v_accvgpr_read_b32 v28, a136
  v_accvgpr_read_b32 v29, a137
  v_accvgpr_read_b32 v30, a138
  v_accvgpr_read_b32 v31, a139
  v_accvgpr_read_b32 v32, a140
  v_accvgpr_read_b32 v33, a141
  v_accvgpr_read_b32 v34, a142
  v_accvgpr_read_b32 v35, a143
  v_perm_b32 v36, v22, v20, s40
  v_perm_b32 v37, v26, v24, s40
  v_perm_b32 v38, v30, v28, s40
  v_perm_b32 v39, v34, v32, s40
  v_perm_b32 v40, v22, v20, s41
  v_perm_b32 v41, v26, v24, s41
  v_perm_b32 v42, v30, v28, s41
  v_perm_b32 v43, v34, v32, s41
  v_perm_b32 v44, v23, v21, s40
  v_perm_b32 v45, v27, v25, s40
  v_perm_b32 v46, v31, v29, s40
  v_perm_b32 v47, v35, v33, s40
  v_perm_b32 v48, v23, v21, s41
  v_perm_b32 v49, v27, v25, s41
  v_perm_b32 v50, v31, v29, s41
  v_perm_b32 v51, v35, v33, s41
  v_accvgpr_write_b32 a128, v36
  v_accvgpr_write_b32 a129, v37
  v_accvgpr_write_b32 a130, v38
  v_accvgpr_write_b32 a131, v39
  v_accvgpr_write_b32 a132, v40
  v_accvgpr_write_b32 a133, v41
  v_accvgpr_write_b32 a134, v42
  v_accvgpr_write_b32 a135, v43
  v_accvgpr_write_b32 a136, v44
  v_accvgpr_write_b32 a137, v45
  v_accvgpr_write_b32 a138, v46
  v_accvgpr_write_b32 a139, v47
  v_accvgpr_write_b32 a140, v48
  v_accvgpr_write_b32 a141, v49
  v_accvgpr_write_b32 a142, v50
  v_accvgpr_write_b32 a143, v51
  v_accvgpr_read_b32 v20, a144
  v_accvgpr_read_b32 v21, a145
  v_accvgpr_read_b32 v22, a146
  v_accvgpr_read_b32 v23, a147
  v_accvgpr_read_b32 v24, a148
  v_accvgpr_read_b32 v25, a149
  v_accvgpr_read_b32 v26, a150
  v_accvgpr_read_b32 v27, a151
  v_accvgpr_read_b32 v28, a152
  v_accvgpr_read_b32 v29, a153
  v_accvgpr_read_b32 v30, a154
  v_accvgpr_read_b32 v31, a155
  v_accvgpr_read_b32 v32, a156
  v_accvgpr_read_b32 v33, a157
  v_accvgpr_read_b32 v34, a158
  v_accvgpr_read_b32 v35, a159
  v_perm_b32 v36, v22, v20, s40
  v_perm_b32 v37, v26, v24, s40
  v_perm_b32 v38, v30, v28, s40
  v_perm_b32 v39, v34, v32, s40
  v_perm_b32 v40, v22, v20, s41
  v_perm_b32 v41, v26, v24, s41
  v_perm_b32 v42, v30, v28, s41
  v_perm_b32 v43, v34, v32, s41
  v_perm_b32 v44, v23, v21, s40
  v_perm_b32 v45, v27, v25, s40
  v_perm_b32 v46, v31, v29, s40
  v_perm_b32 v47, v35, v33, s40
  v_perm_b32 v48, v23, v21, s41
  v_perm_b32 v49, v27, v25, s41
  v_perm_b32 v50, v31, v29, s41
  v_perm_b32 v51, v35, v33, s41
  v_accvgpr_write_b32 a144, v36
  v_accvgpr_write_b32 a145, v37
  v_accvgpr_write_b32 a146, v38
  v_accvgpr_write_b32 a147, v39
  v_accvgpr_write_b32 a148, v40
  v_accvgpr_write_b32 a149, v41
  v_accvgpr_write_b32 a150, v42
  v_accvgpr_write_b32 a151, v43
  v_accvgpr_write_b32 a152, v44
  v_accvgpr_write_b32 a153, v45
  v_accvgpr_write_b32 a154, v46
  v_accvgpr_write_b32 a155, v47
  v_accvgpr_write_b32 a156, v48
  v_accvgpr_write_b32 a157, v49
  v_accvgpr_write_b32 a158, v50
  v_accvgpr_write_b32 a159, v51
  s_branch L_hook_ret
L_wp1:
  s_branch L_hook_ret
  s_cmp_eq_u32 s53, 2
  s_cbranch_scc0 L_hook_ret
  v_accvgpr_read_b32 v20, a96
  v_accvgpr_read_b32 v21, a97
  v_accvgpr_read_b32 v22, a98
  v_accvgpr_read_b32 v23, a99
  v_accvgpr_read_b32 v24, a100
  v_accvgpr_read_b32 v25, a101
  v_accvgpr_read_b32 v26, a102
  v_accvgpr_read_b32 v27, a103
  v_perm_b32 v28, v21, v20, s40
  v_perm_b32 v29, v23, v22, s40
  v_perm_b32 v30, v25, v24, s40
  v_perm_b32 v31, v27, v26, s40
  v_perm_b32 v32, v21, v20, s41
  v_perm_b32 v33, v23, v22, s41
  v_perm_b32 v34, v25, v24, s41
  v_perm_b32 v35, v27, v26, s41
  v_accvgpr_write_b32 a96, v28
  v_accvgpr_write_b32 a97, v29
  v_accvgpr_write_b32 a98, v30
  v_accvgpr_write_b32 a99, v31
  v_accvgpr_write_b32 a100, v32
  v_accvgpr_write_b32 a101, v33
  v_accvgpr_write_b32 a102, v34
  v_accvgpr_write_b32 a103, v35
  v_accvgpr_read_b32 v20, a104
  v_accvgpr_read_b32 v21, a105
  v_accvgpr_read_b32 v22, a106
  v_accvgpr_read_b32 v23, a107
  v_accvgpr_read_b32 v24, a108
  v_accvgpr_read_b32 v25, a109
  v_accvgpr_read_b32 v26, a110
  v_accvgpr_read_b32 v27, a111
  v_perm_b32 v28, v21, v20, s40
  v_perm_b32 v29, v23, v22, s40
  v_perm_b32 v30, v25, v24, s40
  v_perm_b32 v31, v27, v26, s40
  v_perm_b32 v32, v21, v20, s41
  v_perm_b32 v33, v23, v22, s41
  v_perm_b32 v34, v25, v24, s41
  v_perm_b32 v35, v27, v26, s41
  v_accvgpr_write_b32 a104, v28
  v_accvgpr_write_b32 a105, v29
  v_accvgpr_write_b32 a106, v30
  v_accvgpr_write_b32 a107, v31
  v_accvgpr_write_b32 a108, v32
  v_accvgpr_write_b32 a109, v33
  v_accvgpr_write_b32 a110, v34
  v_accvgpr_write_b32 a111, v35
  v_accvgpr_read_b32 v20, a112
  v_accvgpr_read_b32 v21, a113
  v_accvgpr_read_b32 v22, a114
  v_accvgpr_read_b32 v23, a115
  v_accvgpr_read_b32 v24, a116
  v_accvgpr_read_b32 v25, a117
  v_accvgpr_read_b32 v26, a118
  v_accvgpr_read_b32 v27, a119
  v_perm_b32 v28, v21, v20, s40
  v_perm_b32 v29, v23, v22, s40
  v_perm_b32 v30, v25, v24, s40
  v_perm_b32 v31, v27, v26, s40
  v_perm_b32 v32, v21, v20, s41
  v_perm_b32 v33, v23, v22, s41
  v_perm_b32 v34, v25, v24, s41
  v_perm_b32 v35, v27, v26, s41
  v_accvgpr_write_b32 a112, v28
  v_accvgpr_write_b32 a113, v29
  v_accvgpr_write_b32 a114, v30
  v_accvgpr_write_b32 a115, v31
  v_accvgpr_write_b32 a116, v32
  v_accvgpr_write_b32 a117, v33
  v_accvgpr_write_b32 a118, v34
  v_accvgpr_write_b32 a119, v35
  v_accvgpr_read_b32 v20, a120
  v_accvgpr_read_b32 v21, a121
  v_accvgpr_read_b32 v22, a122
  v_accvgpr_read_b32 v23, a123
  v_accvgpr_read_b32 v24, a124
  v_accvgpr_read_b32 v25, a125
  v_accvgpr_read_b32 v26, a126
  v_accvgpr_read_b32 v27, a127
  v_perm_b32 v28, v21, v20, s40
  v_perm_b32 v29, v23, v22, s40
  v_perm_b32 v30, v25, v24, s40
  v_perm_b32 v31, v27, v26, s40
  v_perm_b32 v32, v21, v20, s41
  v_perm_b32 v33, v23, v22, s41
  v_perm_b32 v34, v25, v24, s41
  v_perm_b32 v35, v27, v26, s41
  v_accvgpr_write_b32 a120, v28
  v_accvgpr_write_b32 a121, v29
  v_accvgpr_write_b32 a122, v30
  v_accvgpr_write_b32 a123, v31
  v_accvgpr_write_b32 a124, v32
  v_accvgpr_write_b32 a125, v33
  v_accvgpr_write_b32 a126, v34
  v_accvgpr_write_b32 a127, v35
  v_accvgpr_read_b32 v20, a128
  v_accvgpr_read_b32 v21, a129
  v_accvgpr_read_b32 v22, a130
  v_accvgpr_read_b32 v23, a131
  v_accvgpr_read_b32 v24, a132
  v_accvgpr_read_b32 v25, a133
  v_accvgpr_read_b32 v26, a134
  v_accvgpr_read_b32 v27, a135
  v_perm_b32 v28, v21, v20, s40
  v_perm_b32 v29, v23, v22, s40
  v_perm_b32 v30, v25, v24, s40
  v_perm_b32 v31, v27, v26, s40
  v_perm_b32 v32, v21, v20, s41
  v_perm_b32 v33, v23, v22, s41
  v_perm_b32 v34, v25, v24, s41
  v_perm_b32 v35, v27, v26, s41
  v_accvgpr_write_b32 a128, v28
  v_accvgpr_write_b32 a129, v29
  v_accvgpr_write_b32 a130, v30
  v_accvgpr_write_b32 a131, v31
  v_accvgpr_write_b32 a132, v32
  v_accvgpr_write_b32 a133, v33
  v_accvgpr_write_b32 a134, v34
  v_accvgpr_write_b32 a135, v35
  v_accvgpr_read_b32 v20, a136
  v_accvgpr_read_b32 v21, a137
  v_accvgpr_read_b32 v22, a138
  v_accvgpr_read_b32 v23, a139
  v_accvgpr_read_b32 v24, a140
  v_accvgpr_read_b32 v25, a141
  v_accvgpr_read_b32 v26, a142
  v_accvgpr_read_b32 v27, a143
  v_perm_b32 v28, v21, v20, s40
  v_perm_b32 v29, v23, v22, s40
  v_perm_b32 v30, v25, v24, s40
  v_perm_b32 v31, v27, v26, s40
  v_perm_b32 v32, v21, v20, s41
  v_perm_b32 v33, v23, v22, s41
  v_perm_b32 v34, v25, v24, s41
  v_perm_b32 v35, v27, v26, s41
  v_accvgpr_write_b32 a136, v28
  v_accvgpr_write_b32 a137, v29
  v_accvgpr_write_b32 a138, v30
  v_accvgpr_write_b32 a139, v31
  v_accvgpr_write_b32 a140, v32
  v_accvgpr_write_b32 a141, v33
  v_accvgpr_write_b32 a142, v34
  v_accvgpr_write_b32 a143, v35
  v_accvgpr_read_b32 v20, a144
  v_accvgpr_read_b32 v21, a145
  v_accvgpr_read_b32 v22, a146
  v_accvgpr_read_b32 v23, a147
  v_accvgpr_read_b32 v24, a148
  v_accvgpr_read_b32 v25, a149
  v_accvgpr_read_b32 v26, a150
  v_accvgpr_read_b32 v27, a151
  v_perm_b32 v28, v21, v20, s40
  v_perm_b32 v29, v23, v22, s40
  v_perm_b32 v30, v25, v24, s40
  v_perm_b32 v31, v27, v26, s40
  v_perm_b32 v32, v21, v20, s41
  v_perm_b32 v33, v23, v22, s41
  v_perm_b32 v34, v25, v24, s41
  v_perm_b32 v35, v27, v26, s41
  v_accvgpr_write_b32 a144, v28
  v_accvgpr_write_b32 a145, v29
  v_accvgpr_write_b32 a146, v30
  v_accvgpr_write_b32 a147, v31
  v_accvgpr_write_b32 a148, v32
  v_accvgpr_write_b32 a149, v33
  v_accvgpr_write_b32 a150, v34
  v_accvgpr_write_b32 a151, v35
  v_accvgpr_read_b32 v20, a152
  v_accvgpr_read_b32 v21, a153
  v_accvgpr_read_b32 v22, a154
  v_accvgpr_read_b32 v23, a155
  v_accvgpr_read_b32 v24, a156
  v_accvgpr_read_b32 v25, a157
  v_accvgpr_read_b32 v26, a158
  v_accvgpr_read_b32 v27, a159
  v_perm_b32 v28, v21, v20, s40
  v_perm_b32 v29, v23, v22, s40
  v_perm_b32 v30, v25, v24, s40
  v_perm_b32 v31, v27, v26, s40
  v_perm_b32 v32, v21, v20, s41
  v_perm_b32 v33, v23, v22, s41
  v_perm_b32 v34, v25, v24, s41
  v_perm_b32 v35, v27, v26, s41
  v_accvgpr_write_b32 a152, v28
  v_accvgpr_write_b32 a153, v29
  v_accvgpr_write_b32 a154, v30
  v_accvgpr_write_b32 a155, v31
  v_accvgpr_write_b32 a156, v32
  v_accvgpr_write_b32 a157, v33
  v_accvgpr_write_b32 a158, v34
  v_accvgpr_write_b32 a159, v35
  v_lshlrev_b32 v200, 16, v196
  v_and_b32 v201, 0xffff0000, v196
  v_lshlrev_b32 v202, 16, v197
  v_and_b32 v203, 0xffff0000, v197
  v_lshlrev_b32 v204, 16, v198
  v_and_b32 v205, 0xffff0000, v198
  v_lshlrev_b32 v206, 16, v199
  v_and_b32 v207, 0xffff0000, v199
  v_mov_b32 v20, 0x3f803f80
  v_mov_b32 v21, 0x3f803f80
  v_lshlrev_b32 v9, 3, v1
  ds_write_b64 v9, v[20:21] offset:27136
  v_accvgpr_read_b32 v20, a160
  v_accvgpr_read_b32 v21, a161
  v_accvgpr_read_b32 v22, a164
  v_accvgpr_read_b32 v23, a165
  v_accvgpr_read_b32 v24, a168
  v_accvgpr_read_b32 v25, a169
  v_accvgpr_read_b32 v26, a172
  v_accvgpr_read_b32 v27, a173
  v_accvgpr_read_b32 v28, a176
  v_accvgpr_read_b32 v29, a177
  v_accvgpr_read_b32 v30, a180
  v_accvgpr_read_b32 v31, a181
  v_accvgpr_read_b32 v32, a184
  v_accvgpr_read_b32 v33, a185
  v_accvgpr_read_b32 v34, a188
  v_accvgpr_read_b32 v35, a189
  v_perm_b32 v36, v22, v20, s40
  v_perm_b32 v37, v26, v24, s40
  v_perm_b32 v38, v30, v28, s40
  v_perm_b32 v39, v34, v32, s40
  v_perm_b32 v40, v22, v20, s41
  v_perm_b32 v41, v26, v24, s41
  v_perm_b32 v42, v30, v28, s41
  v_perm_b32 v43, v34, v32, s41
  v_perm_b32 v44, v23, v21, s40
  v_perm_b32 v45, v27, v25, s40
  v_perm_b32 v46, v31, v29, s40
  v_perm_b32 v47, v35, v33, s40
  v_perm_b32 v48, v23, v21, s41
  v_perm_b32 v49, v27, v25, s41
  v_perm_b32 v50, v31, v29, s41
  v_perm_b32 v51, v35, v33, s41
  v_accvgpr_write_b32 a192, v36
  v_accvgpr_write_b32 a193, v37
  v_accvgpr_write_b32 a194, v38
  v_accvgpr_write_b32 a195, v39
  v_accvgpr_write_b32 a196, v40
  v_accvgpr_write_b32 a197, v41
  v_accvgpr_write_b32 a198, v42
  v_accvgpr_write_b32 a199, v43
  v_accvgpr_write_b32 a200, v44
  v_accvgpr_write_b32 a201, v45
  v_accvgpr_write_b32 a202, v46
  v_accvgpr_write_b32 a203, v47
  v_accvgpr_write_b32 a204, v48
  v_accvgpr_write_b32 a205, v49
  v_accvgpr_write_b32 a206, v50
  v_accvgpr_write_b32 a207, v51
  v_accvgpr_read_b32 v20, a162
  v_accvgpr_read_b32 v21, a163
  v_accvgpr_read_b32 v22, a166
  v_accvgpr_read_b32 v23, a167
  v_accvgpr_read_b32 v24, a170
  v_accvgpr_read_b32 v25, a171
  v_accvgpr_read_b32 v26, a174
  v_accvgpr_read_b32 v27, a175
  v_accvgpr_read_b32 v28, a178
  v_accvgpr_read_b32 v29, a179
  v_accvgpr_read_b32 v30, a182
  v_accvgpr_read_b32 v31, a183
  v_accvgpr_read_b32 v32, a186
  v_accvgpr_read_b32 v33, a187
  v_accvgpr_read_b32 v34, a190
  v_accvgpr_read_b32 v35, a191
  v_perm_b32 v36, v22, v20, s40
  v_perm_b32 v37, v26, v24, s40
  v_perm_b32 v38, v30, v28, s40
  v_perm_b32 v39, v34, v32, s40
  v_perm_b32 v40, v22, v20, s41
  v_perm_b32 v41, v26, v24, s41
  v_perm_b32 v42, v30, v28, s41
  v_perm_b32 v43, v34, v32, s41
  v_perm_b32 v44, v23, v21, s40
  v_perm_b32 v45, v27, v25, s40
  v_perm_b32 v46, v31, v29, s40
  v_perm_b32 v47, v35, v33, s40
  v_perm_b32 v48, v23, v21, s41
  v_perm_b32 v49, v27, v25, s41
  v_perm_b32 v50, v31, v29, s41
  v_perm_b32 v51, v35, v33, s41
  v_accvgpr_write_b32 a208, v36
  v_accvgpr_write_b32 a209, v37
  v_accvgpr_write_b32 a210, v38
  v_accvgpr_write_b32 a211, v39
  v_accvgpr_write_b32 a212, v40
  v_accvgpr_write_b32 a213, v41
  v_accvgpr_write_b32 a214, v42
  v_accvgpr_write_b32 a215, v43
  v_accvgpr_write_b32 a216, v44
  v_accvgpr_write_b32 a217, v45
  v_accvgpr_write_b32 a218, v46
  v_accvgpr_write_b32 a219, v47
  v_accvgpr_write_b32 a220, v48
  v_accvgpr_write_b32 a221, v49
  v_accvgpr_write_b32 a222, v50
  v_accvgpr_write_b32 a223, v51
  s_branch L_hook_ret
L_fin:
  v_add_f32 v9, v12, v13
  v_mov_b32 v11, v9
  s_nop 1
  v_permlane16_swap_b32 v9, v11
  v_add_f32 v9, v9, v11
  v_mov_b32 v11, v9
  s_nop 1
  v_permlane32_swap_b32 v9, v11
  v_add_f32 v9, v9, v11
  v_and_b32 v12, 15, v1
  v_lshrrev_b32 v13, 4, v1
  v_lshlrev_b32 v14, 9, v12
  v_lshl_add_u32 v14, v13, 7, v14
  s_lshl_b32 s47, s3, 11
  v_add_u32 v14, s47, v14
  v_lshlrev_b32 v15, 3, v12
  s_lshl_b32 s47, s3, 5
  v_add_u32 v15, s47, v15
  s_mov_b32 s50, 0x000f000f
  s_mov_b32 s51, 0x000f000f
  s_mov_b64 exec, s[50:51]
  ds_write_b128 v14, v[52:55] offset:0
  ds_write_b128 v14, v[56:59] offset:16
  ds_write_b128 v14, v[60:63] offset:32
  ds_write_b128 v14, v[64:67] offset:48
  ds_write_b128 v14, v[68:71] offset:64
  ds_write_b128 v14, v[72:75] offset:80
  ds_write_b128 v14, v[76:79] offset:96
  ds_write_b128 v14, v[80:83] offset:112
  ds_write_b64 v15, v[8:9] offset:8192
  s_mov_b64 exec, -1
  v_and_b32 v16, 31, v1
  v_lshlrev_b32 v14, 4, v16
  s_lshl_b32 s47, s3, 9
  v_add_u32 v14, s47, v14
  s_lshl_b32 s47, s3, 3
  v_mov_b32 v15, s47
  s_lshl_b32 s47, s42, 15
  s_lshl_b32 s48, s3, 13
  s_add_u32 s47, s47, s48
  s_lshl_b32 s48, s45, 10
  s_add_u32 s47, s47, s48
  s_lshl_b32 s48, s44, 8
  s_add_u32 s47, s47, s48
  s_add_u32 s47, s47, 1048576
  v_lshl_add_u32 v48, v16, 3, s47
  s_lshl_b32 s47, s42, 12
  s_lshl_b32 s48, s3, 10
  s_add_u32 s47, s47, s48
  s_lshl_b32 s48, s45, 7
  s_add_u32 s47, s47, s48
  s_lshl_b32 s48, s44, 2
  s_add_u32 s47, s47, s48
  s_add_u32 s47, s47, 1572864
  v_mov_b32 v49, s47
  s_waitcnt lgkmcnt(0)
  s_barrier
  ds_read_b64 v[36:37], v15 offset:8192
  ds_read_b64 v[38:39], v15 offset:8224
  ds_read_b64 v[40:41], v15 offset:8256
  ds_read_b64 v[42:43], v15 offset:8288
  ds_read_b128 v[20:23], v14 offset:0
  ds_read_b128 v[24:27], v14 offset:2048
  ds_read_b128 v[28:31], v14 offset:4096
  ds_read_b128 v[32:35], v14 offset:6144
  s_waitcnt lgkmcnt(4)
  v_max3_f32 v44, v36, v38, v40
  v_max_f32 v44, v44, v42
  v_sub_f32 v36, v36, v44
  v_sub_f32 v38, v38, v44
  v_sub_f32 v40, v40, v44
  v_sub_f32 v42, v42, v44
  v_mul_f32 v36, s39, v36
  v_mul_f32 v38, s39, v38
  v_mul_f32 v40, s39, v40
  v_mul_f32 v42, s39, v42
  v_exp_f32 v36, v36
  v_exp_f32 v38, v38
  v_exp_f32 v40, v40
  v_exp_f32 v42, v42
  v_mul_f32 v45, v36, v37
  v_fmac_f32 v45, v38, v39
  v_fmac_f32 v45, v40, v41
  v_fmac_f32 v45, v42, v43
  v_rcp_f32 v46, v45
  v_log_f32 v47, v45
  s_waitcnt lgkmcnt(0)
  v_mul_f32 v20, v36, v20
  v_mul_f32 v21, v36, v21
  v_mul_f32 v22, v36, v22
  v_mul_f32 v23, v36, v23
  v_fmac_f32 v20, v38, v24
  v_fmac_f32 v21, v38, v25
  v_fmac_f32 v22, v38, v26
  v_fmac_f32 v23, v38, v27
  v_fmac_f32 v20, v40, v28
  v_fmac_f32 v21, v40, v29
  v_fmac_f32 v22, v40, v30
  v_fmac_f32 v23, v40, v31
  v_fmac_f32 v20, v42, v32
  v_fmac_f32 v21, v42, v33
  v_fmac_f32 v22, v42, v34
  v_fmac_f32 v23, v42, v35
  v_mul_f32 v20, v20, v46
  v_mul_f32 v21, v21, v46
  v_mul_f32 v22, v22, v46
  v_mul_f32 v23, v23, v46
  v_fma_f32 v47, v44, s39, v47
  v_cvt_pk_bf16_f32 v20, v20, v21
  v_cvt_pk_bf16_f32 v21, v22, v23
  s_mov_b32 s50, 0x55555555
  s_mov_b32 s51, 0
  v_mov_b32_dpp v22, v20 quad_perm:[1,0,3,2] row_mask:0xf bank_mask:0xf
  v_mov_b32_dpp v23, v21 quad_perm:[1,0,3,2] row_mask:0xf bank_mask:0xf
  s_mov_b64 exec, s[50:51]
  global_store_dwordx4 v48, v[20:23], s[26:27] sc1
  s_mov_b64 exec, 1
  global_store_dword v49, v47, s[26:27] sc1
  s_mov_b64 exec, -1
  s_cmp_eq_u32 s53, 0
  s_cbranch_scc1 L_done
  v_and_b32 v2, 15, v1
  v_lshrrev_b32 v3, 4, v1
  v_and_b32 v4, 3, v1
  s_cmp_eq_u32 s53, 2
  s_cbranch_scc1 L_roleC
  s_lshr_b32 s42, s54, 3
  s_and_b32 s43, s54, 7
  s_lshl_b32 s47, s42, 15
  s_lshl_b32 s48, s3, 13
  s_add_u32 s47, s47, s48
  s_add_u32 s47, s47, 1048576
  v_lshl_add_u32 v6, v1, 4, s47
  v_add_u32 v7, 0x1000, v6
  s_lshl_b32 s47, s42, 12
  s_lshl_b32 s48, s3, 10
  s_add_u32 s47, s47, s48
  s_add_u32 s47, s47, 1572864
  v_lshl_add_u32 v8, v3, 2, s47
  s_lshl_b32 s47, s3, 10
  v_lshl_add_u32 v9, v1, 4, s47
  v_lshlrev_b32 v10, 8, v4
  v_lshl_add_u32 v10, v3, 4, v10
  v_add_u32 v10, s47, v10
  v_lshl_add_u32 v11, v1, 4, s47
  s_mov_b32 s62, 0
  s_mov_b32 s65, 262144
  s_waitcnt vmcnt(24)
  v_perm_b32 v228, v166, v164, s40
  v_perm_b32 v229, v170, v168, s40
  v_perm_b32 v230, v174, v172, s40
  v_perm_b32 v231, v178, v176, s40
  v_perm_b32 v232, v166, v164, s41
  v_perm_b32 v233, v170, v168, s41
  v_perm_b32 v234, v174, v172, s41
  v_perm_b32 v235, v178, v176, s41
  v_perm_b32 v236, v167, v165, s40
  v_perm_b32 v237, v171, v169, s40
  v_perm_b32 v238, v175, v173, s40
  v_perm_b32 v239, v179, v177, s40
  v_perm_b32 v240, v167, v165, s41
  v_perm_b32 v241, v171, v169, s41
  v_perm_b32 v242, v175, v173, s41
  v_perm_b32 v243, v179, v177, s41
  s_waitcnt vmcnt(16)
  v_perm_b32 v164, v182, v180, s40
  v_perm_b32 v165, v186, v184, s40
  v_perm_b32 v166, v190, v188, s40
  v_perm_b32 v167, v194, v192, s40
  v_perm_b32 v168, v182, v180, s41
  v_perm_b32 v169, v186, v184, s41
  v_perm_b32 v170, v190, v188, s41
  v_perm_b32 v171, v194, v192, s41
  v_perm_b32 v172, v183, v181, s40
  v_perm_b32 v173, v187, v185, s40
  v_perm_b32 v174, v191, v189, s40
  v_perm_b32 v175, v195, v193, s40
  v_perm_b32 v176, v183, v181, s41
  v_perm_b32 v177, v187, v185, s41
  v_perm_b32 v178, v191, v189, s41
  v_perm_b32 v179, v195, v193, s41
  s_waitcnt vmcnt(8)
  v_perm_b32 v180, v198, v196, s40
  v_perm_b32 v181, v202, v200, s40
  v_perm_b32 v182, v206, v204, s40
  v_perm_b32 v183, v210, v208, s40
  v_perm_b32 v184, v198, v196, s41
  v_perm_b32 v185, v202, v200, s41
  v_perm_b32 v186, v206, v204, s41
  v_perm_b32 v187, v210, v208, s41
  v_perm_b32 v188, v199, v197, s40
  v_perm_b32 v189, v203, v201, s40
  v_perm_b32 v190, v207, v205, s40
  v_perm_b32 v191, v211, v209, s40
  v_perm_b32 v192, v199, v197, s41
  v_perm_b32 v193, v203, v201, s41
  v_perm_b32 v194, v207, v205, s41
  v_perm_b32 v195, v211, v209, s41
  s_waitcnt vmcnt(0)
  v_perm_b32 v196, v214, v212, s40
  v_perm_b32 v197, v218, v216, s40
  v_perm_b32 v198, v222, v220, s40
  v_perm_b32 v199, v226, v224, s40
  v_perm_b32 v200, v214, v212, s41
  v_perm_b32 v201, v218, v216, s41
  v_perm_b32 v202, v222, v220, s41
  v_perm_b32 v203, v226, v224, s41
  v_perm_b32 v204, v215, v213, s40
  v_perm_b32 v205, v219, v217, s40
  v_perm_b32 v206, v223, v221, s40
  v_perm_b32 v207, v227, v225, s40
  v_perm_b32 v208, v215, v213, s41
  v_perm_b32 v209, v219, v217, s41
  v_perm_b32 v210, v223, v221, s41
  v_perm_b32 v211, v227, v225, s41
L_binit:
  s_mov_b32 s61, 0xff
  v_mov_b32 v12, 0xff800000
  v_mov_b32 v13, 0
  v_mov_b32 v64, 0
  v_mov_b32 v65, 0
  v_mov_b32 v66, 0
  v_mov_b32 v67, 0
  v_mov_b32 v68, 0
  v_mov_b32 v69, 0
  v_mov_b32 v70, 0
  v_mov_b32 v71, 0
L_bpoll:
  s_bitcmp1_b32 s61, 0
  s_cbranch_scc0 L_bl0
  global_load_dword v16, v8, s[26:27] offset:0 sc1
  global_load_dwordx4 v[32:35], v6, s[26:27] offset:0 sc1
L_bl0:
  s_bitcmp1_b32 s61, 1
  s_cbranch_scc0 L_bl1
  global_load_dword v17, v8, s[26:27] offset:128 sc1
  global_load_dwordx4 v[36:39], v6, s[26:27] offset:1024 sc1
L_bl1:
  s_bitcmp1_b32 s61, 2
  s_cbranch_scc0 L_bl2
  global_load_dword v18, v8, s[26:27] offset:256 sc1
  global_load_dwordx4 v[40:43], v6, s[26:27] offset:2048 sc1
L_bl2:
  s_bitcmp1_b32 s61, 3
  s_cbranch_scc0 L_bl3
  global_load_dword v19, v8, s[26:27] offset:384 sc1
  global_load_dwordx4 v[44:47], v6, s[26:27] offset:3072 sc1
L_bl3:
  s_bitcmp1_b32 s61, 4
  s_cbranch_scc0 L_bl4
  global_load_dword v20, v8, s[26:27] offset:512 sc1
  global_load_dwordx4 v[48:51], v7, s[26:27] offset:0 sc1
L_bl4:
  s_bitcmp1_b32 s61, 5
  s_cbranch_scc0 L_bl5
  global_load_dword v21, v8, s[26:27] offset:640 sc1
  global_load_dwordx4 v[52:55], v7, s[26:27] offset:1024 sc1
L_bl5:
  s_bitcmp1_b32 s61, 6
  s_cbranch_scc0 L_bl6
  global_load_dword v22, v8, s[26:27] offset:768 sc1
  global_load_dwordx4 v[56:59], v7, s[26:27] offset:2048 sc1
L_bl6:
  s_bitcmp1_b32 s61, 7
  s_cbranch_scc0 L_bl7
  global_load_dword v23, v8, s[26:27] offset:896 sc1
  global_load_dwordx4 v[60:63], v7, s[26:27] offset:3072 sc1
L_bl7:
  s_waitcnt vmcnt(0)
  s_bitcmp1_b32 s61, 0
  s_cbranch_scc0 L_bn0
  v_max_u32 v14, v16, v32
  v_cmp_eq_u32 vcc, -1, v14
  s_nop 0
  s_cbranch_vccnz L_bn0
  s_bitset0_b32 s61, 0
  v_max_f32 v14, v12, v16
  v_sub_f32 v15, v12, v14
  v_sub_f32 v72, v16, v14
  v_exp_f32 v15, v15
  v_exp_f32 v72, v72
  v_mov_b32 v12, v14
  v_lshlrev_b32 v76, 16, v32
  v_and_b32 v77, 0xffff0000, v32
  v_lshlrev_b32 v78, 16, v33
  v_and_b32 v79, 0xffff0000, v33
  v_lshlrev_b32 v80, 16, v34
  v_and_b32 v81, 0xffff0000, v34
  v_lshlrev_b32 v82, 16, v35
  v_and_b32 v83, 0xffff0000, v35
  v_fma_f32 v13, v13, v15, v72
  v_pk_mul_f32 v[64:65], v[64:65], v[14:15] op_sel:[0,1] op_sel_hi:[1,1]
  v_pk_mul_f32 v[66:67], v[66:67], v[14:15] op_sel:[0,1] op_sel_hi:[1,1]
  v_pk_mul_f32 v[68:69], v[68:69], v[14:15] op_sel:[0,1] op_sel_hi:[1,1]
  v_pk_mul_f32 v[70:71], v[70:71], v[14:15] op_sel:[0,1] op_sel_hi:[1,1]
  v_pk_fma_f32 v[64:65], v[76:77], v[72:73], v[64:65] op_sel:[0,0,0] op_sel_hi:[1,0,1]
  v_pk_fma_f32 v[66:67], v[78:79], v[72:73], v[66:67] op_sel:[0,0,0] op_sel_hi:[1,0,1]
  v_pk_fma_f32 v[68:69], v[80:81], v[72:73], v[68:69] op_sel:[0,0,0] op_sel_hi:[1,0,1]
  v_pk_fma_f32 v[70:71], v[82:83], v[72:73], v[70:71] op_sel:[0,0,0] op_sel_hi:[1,0,1]
L_bn0:
  s_bitcmp1_b32 s61, 1
  s_cbranch_scc0 L_bn1
  v_max_u32 v14, v17, v36
  v_cmp_eq_u32 vcc, -1, v14
  s_nop 0
  s_cbranch_vccnz L_bn1
  s_bitset0_b32 s61, 1
  v_max_f32 v14, v12, v17
  v_sub_f32 v15, v12, v14
  v_sub_f32 v72, v17, v14
  v_exp_f32 v15, v15
  v_exp_f32 v72, v72
  v_mov_b32 v12, v14
  v_lshlrev_b32 v76, 16, v36
  v_and_b32 v77, 0xffff0000, v36
  v_lshlrev_b32 v78, 16, v37
  v_and_b32 v79, 0xffff0000, v37
  v_lshlrev_b32 v80, 16, v38
  v_and_b32 v81, 0xffff0000, v38
  v_lshlrev_b32 v82, 16, v39
  v_and_b32 v83, 0xffff0000, v39
  v_fma_f32 v13, v13, v15, v72
  v_pk_mul_f32 v[64:65], v[64:65], v[14:15] op_sel:[0,1] op_sel_hi:[1,1]
  v_pk_mul_f32 v[66:67], v[66:67], v[14:15] op_sel:[0,1] op_sel_hi:[1,1]
  v_pk_mul_f32 v[68:69], v[68:69], v[14:15] op_sel:[0,1] op_sel_hi:[1,1]
  v_pk_mul_f32 v[70:71], v[70:71], v[14:15] op_sel:[0,1] op_sel_hi:[1,1]
  v_pk_fma_f32 v[64:65], v[76:77], v[72:73], v[64:65] op_sel:[0,0,0] op_sel_hi:[1,0,1]
  v_pk_fma_f32 v[66:67], v[78:79], v[72:73], v[66:67] op_sel:[0,0,0] op_sel_hi:[1,0,1]
  v_pk_fma_f32 v[68:69], v[80:81], v[72:73], v[68:69] op_sel:[0,0,0] op_sel_hi:[1,0,1]
  v_pk_fma_f32 v[70:71], v[82:83], v[72:73], v[70:71] op_sel:[0,0,0] op_sel_hi:[1,0,1]
L_bn1:
  s_bitcmp1_b32 s61, 2
  s_cbranch_scc0 L_bn2
  v_max_u32 v14, v18, v40
  v_cmp_eq_u32 vcc, -1, v14
  s_nop 0
  s_cbranch_vccnz L_bn2
  s_bitset0_b32 s61, 2
  v_max_f32 v14, v12, v18
  v_sub_f32 v15, v12, v14
  v_sub_f32 v72, v18, v14
  v_exp_f32 v15, v15
  v_exp_f32 v72, v72
  v_mov_b32 v12, v14
  v_lshlrev_b32 v76, 16, v40
  v_and_b32 v77, 0xffff0000, v40
  v_lshlrev_b32 v78, 16, v41
  v_and_b32 v79, 0xffff0000, v41
  v_lshlrev_b32 v80, 16, v42
  v_and_b32 v81, 0xffff0000, v42
  v_lshlrev_b32 v82, 16, v43
  v_and_b32 v83, 0xffff0000, v43
  v_fma_f32 v13, v13, v15, v72
  v_pk_mul_f32 v[64:65], v[64:65], v[14:15] op_sel:[0,1] op_sel_hi:[1,1]
  v_pk_mul_f32 v[66:67], v[66:67], v[14:15] op_sel:[0,1] op_sel_hi:[1,1]
  v_pk_mul_f32 v[68:69], v[68:69], v[14:15] op_sel:[0,1] op_sel_hi:[1,1]
  v_pk_mul_f32 v[70:71], v[70:71], v[14:15] op_sel:[0,1] op_sel_hi:[1,1]
  v_pk_fma_f32 v[64:65], v[76:77], v[72:73], v[64:65] op_sel:[0,0,0] op_sel_hi:[1,0,1]
  v_pk_fma_f32 v[66:67], v[78:79], v[72:73], v[66:67] op_sel:[0,0,0] op_sel_hi:[1,0,1]
  v_pk_fma_f32 v[68:69], v[80:81], v[72:73], v[68:69] op_sel:[0,0,0] op_sel_hi:[1,0,1]
  v_pk_fma_f32 v[70:71], v[82:83], v[72:73], v[70:71] op_sel:[0,0,0] op_sel_hi:[1,0,1]
L_bn2:
  s_bitcmp1_b32 s61, 3
  s_cbranch_scc0 L_bn3
  v_max_u32 v14, v19, v44
  v_cmp_eq_u32 vcc, -1, v14
  s_nop 0
  s_cbranch_vccnz L_bn3
  s_bitset0_b32 s61, 3
  v_max_f32 v14, v12, v19
  v_sub_f32 v15, v12, v14
  v_sub_f32 v72, v19, v14
  v_exp_f32 v15, v15
  v_exp_f32 v72, v72
  v_mov_b32 v12, v14
  v_lshlrev_b32 v76, 16, v44
  v_and_b32 v77, 0xffff0000, v44
  v_lshlrev_b32 v78, 16, v45
  v_and_b32 v79, 0xffff0000, v45
  v_lshlrev_b32 v80, 16, v46
  v_and_b32 v81, 0xffff0000, v46
  v_lshlrev_b32 v82, 16, v47
  v_and_b32 v83, 0xffff0000, v47
  v_fma_f32 v13, v13, v15, v72
  v_pk_mul_f32 v[64:65], v[64:65], v[14:15] op_sel:[0,1] op_sel_hi:[1,1]
  v_pk_mul_f32 v[66:67], v[66:67], v[14:15] op_sel:[0,1] op_sel_hi:[1,1]
  v_pk_mul_f32 v[68:69], v[68:69], v[14:15] op_sel:[0,1] op_sel_hi:[1,1]
  v_pk_mul_f32 v[70:71], v[70:71], v[14:15] op_sel:[0,1] op_sel_hi:[1,1]
  v_pk_fma_f32 v[64:65], v[76:77], v[72:73], v[64:65] op_sel:[0,0,0] op_sel_hi:[1,0,1]
  v_pk_fma_f32 v[66:67], v[78:79], v[72:73], v[66:67] op_sel:[0,0,0] op_sel_hi:[1,0,1]
  v_pk_fma_f32 v[68:69], v[80:81], v[72:73], v[68:69] op_sel:[0,0,0] op_sel_hi:[1,0,1]
  v_pk_fma_f32 v[70:71], v[82:83], v[72:73], v[70:71] op_sel:[0,0,0] op_sel_hi:[1,0,1]
L_bn3:
  s_bitcmp1_b32 s61, 4
  s_cbranch_scc0 L_bn4
  v_max_u32 v14, v20, v48
  v_cmp_eq_u32 vcc, -1, v14
  s_nop 0
  s_cbranch_vccnz L_bn4
  s_bitset0_b32 s61, 4
  v_max_f32 v14, v12, v20
  v_sub_f32 v15, v12, v14
  v_sub_f32 v72, v20, v14
  v_exp_f32 v15, v15
  v_exp_f32 v72, v72
  v_mov_b32 v12, v14
  v_lshlrev_b32 v76, 16, v48
  v_and_b32 v77, 0xffff0000, v48
  v_lshlrev_b32 v78, 16, v49
  v_and_b32 v79, 0xffff0000, v49
  v_lshlrev_b32 v80, 16, v50
  v_and_b32 v81, 0xffff0000, v50
  v_lshlrev_b32 v82, 16, v51
  v_and_b32 v83, 0xffff0000, v51
  v_fma_f32 v13, v13, v15, v72
  v_pk_mul_f32 v[64:65], v[64:65], v[14:15] op_sel:[0,1] op_sel_hi:[1,1]
  v_pk_mul_f32 v[66:67], v[66:67], v[14:15] op_sel:[0,1] op_sel_hi:[1,1]
  v_pk_mul_f32 v[68:69], v[68:69], v[14:15] op_sel:[0,1] op_sel_hi:[1,1]
  v_pk_mul_f32 v[70:71], v[70:71], v[14:15] op_sel:[0,1] op_sel_hi:[1,1]
  v_pk_fma_f32 v[64:65], v[76:77], v[72:73], v[64:65] op_sel:[0,0,0] op_sel_hi:[1,0,1]
  v_pk_fma_f32 v[66:67], v[78:79], v[72:73], v[66:67] op_sel:[0,0,0] op_sel_hi:[1,0,1]
  v_pk_fma_f32 v[68:69], v[80:81], v[72:73], v[68:69] op_sel:[0,0,0] op_sel_hi:[1,0,1]
  v_pk_fma_f32 v[70:71], v[82:83], v[72:73], v[70:71] op_sel:[0,0,0] op_sel_hi:[1,0,1]
L_bn4:
  s_bitcmp1_b32 s61, 5
  s_cbranch_scc0 L_bn5
  v_max_u32 v14, v21, v52
  v_cmp_eq_u32 vcc, -1, v14
  s_nop 0
  s_cbranch_vccnz L_bn5
  s_bitset0_b32 s61, 5
  v_max_f32 v14, v12, v21
  v_sub_f32 v15, v12, v14
  v_sub_f32 v72, v21, v14
  v_exp_f32 v15, v15
  v_exp_f32 v72, v72
  v_mov_b32 v12, v14
  v_lshlrev_b32 v76, 16, v52
  v_and_b32 v77, 0xffff0000, v52
  v_lshlrev_b32 v78, 16, v53
  v_and_b32 v79, 0xffff0000, v53
  v_lshlrev_b32 v80, 16, v54
  v_and_b32 v81, 0xffff0000, v54
  v_lshlrev_b32 v82, 16, v55
  v_and_b32 v83, 0xffff0000, v55
  v_fma_f32 v13, v13, v15, v72
  v_pk_mul_f32 v[64:65], v[64:65], v[14:15] op_sel:[0,1] op_sel_hi:[1,1]
  v_pk_mul_f32 v[66:67], v[66:67], v[14:15] op_sel:[0,1] op_sel_hi:[1,1]
  v_pk_mul_f32 v[68:69], v[68:69], v[14:15] op_sel:[0,1] op_sel_hi:[1,1]
  v_pk_mul_f32 v[70:71], v[70:71], v[14:15] op_sel:[0,1] op_sel_hi:[1,1]
  v_pk_fma_f32 v[64:65], v[76:77], v[72:73], v[64:65] op_sel:[0,0,0] op_sel_hi:[1,0,1]
  v_pk_fma_f32 v[66:67], v[78:79], v[72:73], v[66:67] op_sel:[0,0,0] op_sel_hi:[1,0,1]
  v_pk_fma_f32 v[68:69], v[80:81], v[72:73], v[68:69] op_sel:[0,0,0] op_sel_hi:[1,0,1]
  v_pk_fma_f32 v[70:71], v[82:83], v[72:73], v[70:71] op_sel:[0,0,0] op_sel_hi:[1,0,1]
L_bn5:
  s_bitcmp1_b32 s61, 6
  s_cbranch_scc0 L_bn6
  v_max_u32 v14, v22, v56
  v_cmp_eq_u32 vcc, -1, v14
  s_nop 0
  s_cbranch_vccnz L_bn6
  s_bitset0_b32 s61, 6
  v_max_f32 v14, v12, v22
  v_sub_f32 v15, v12, v14
  v_sub_f32 v72, v22, v14
  v_exp_f32 v15, v15
  v_exp_f32 v72, v72
  v_mov_b32 v12, v14
  v_lshlrev_b32 v76, 16, v56
  v_and_b32 v77, 0xffff0000, v56
  v_lshlrev_b32 v78, 16, v57
  v_and_b32 v79, 0xffff0000, v57
  v_lshlrev_b32 v80, 16, v58
  v_and_b32 v81, 0xffff0000, v58
  v_lshlrev_b32 v82, 16, v59
  v_and_b32 v83, 0xffff0000, v59
  v_fma_f32 v13, v13, v15, v72
  v_pk_mul_f32 v[64:65], v[64:65], v[14:15] op_sel:[0,1] op_sel_hi:[1,1]
  v_pk_mul_f32 v[66:67], v[66:67], v[14:15] op_sel:[0,1] op_sel_hi:[1,1]
  v_pk_mul_f32 v[68:69], v[68:69], v[14:15] op_sel:[0,1] op_sel_hi:[1,1]
  v_pk_mul_f32 v[70:71], v[70:71], v[14:15] op_sel:[0,1] op_sel_hi:[1,1]
  v_pk_fma_f32 v[64:65], v[76:77], v[72:73], v[64:65] op_sel:[0,0,0] op_sel_hi:[1,0,1]
  v_pk_fma_f32 v[66:67], v[78:79], v[72:73], v[66:67] op_sel:[0,0,0] op_sel_hi:[1,0,1]
  v_pk_fma_f32 v[68:69], v[80:81], v[72:73], v[68:69] op_sel:[0,0,0] op_sel_hi:[1,0,1]
  v_pk_fma_f32 v[70:71], v[82:83], v[72:73], v[70:71] op_sel:[0,0,0] op_sel_hi:[1,0,1]
L_bn6:
  s_bitcmp1_b32 s61, 7
  s_cbranch_scc0 L_bn7
  v_max_u32 v14, v23, v60
  v_cmp_eq_u32 vcc, -1, v14
  s_nop 0
  s_cbranch_vccnz L_bn7
  s_bitset0_b32 s61, 7
  v_max_f32 v14, v12, v23
  v_sub_f32 v15, v12, v14
  v_sub_f32 v72, v23, v14
  v_exp_f32 v15, v15
  v_exp_f32 v72, v72
  v_mov_b32 v12, v14
  v_lshlrev_b32 v76, 16, v60
  v_and_b32 v77, 0xffff0000, v60
  v_lshlrev_b32 v78, 16, v61
  v_and_b32 v79, 0xffff0000, v61
  v_lshlrev_b32 v80, 16, v62
  v_and_b32 v81, 0xffff0000, v62
  v_lshlrev_b32 v82, 16, v63
  v_and_b32 v83, 0xffff0000, v63
  v_fma_f32 v13, v13, v15, v72
  v_pk_mul_f32 v[64:65], v[64:65], v[14:15] op_sel:[0,1] op_sel_hi:[1,1]
  v_pk_mul_f32 v[66:67], v[66:67], v[14:15] op_sel:[0,1] op_sel_hi:[1,1]
  v_pk_mul_f32 v[68:69], v[68:69], v[14:15] op_sel:[0,1] op_sel_hi:[1,1]
  v_pk_mul_f32 v[70:71], v[70:71], v[14:15] op_sel:[0,1] op_sel_hi:[1,1]
  v_pk_fma_f32 v[64:65], v[76:77], v[72:73], v[64:65] op_sel:[0,0,0] op_sel_hi:[1,0,1]
  v_pk_fma_f32 v[66:67], v[78:79], v[72:73], v[66:67] op_sel:[0,0,0] op_sel_hi:[1,0,1]
  v_pk_fma_f32 v[68:69], v[80:81], v[72:73], v[68:69] op_sel:[0,0,0] op_sel_hi:[1,0,1]
  v_pk_fma_f32 v[70:71], v[82:83], v[72:73], v[70:71] op_sel:[0,0,0] op_sel_hi:[1,0,1]
L_bn7:
  s_sub_u32 s65, s65, 1
  s_cmp_eq_u32 s65, 0
  s_cbranch_scc1 L_bgo
  s_cmp_lg_u32 s61, 0
  s_cbranch_scc1 L_bpoll
L_bgo:
  v_rcp_f32 v12, v13
  s_nop 0
  v_pk_mul_f32 v[64:65], v[64:65], v[12:13] op_sel:[0,0] op_sel_hi:[1,0]
  v_pk_mul_f32 v[66:67], v[66:67], v[12:13] op_sel:[0,0] op_sel_hi:[1,0]
  v_pk_mul_f32 v[68:69], v[68:69], v[12:13] op_sel:[0,0] op_sel_hi:[1,0]
  v_pk_mul_f32 v[70:71], v[70:71], v[12:13] op_sel:[0,0] op_sel_hi:[1,0]
  v_cvt_pk_bf16_f32 v76, v64, v65
  v_cvt_pk_bf16_f32 v77, v66, v67
  v_cvt_pk_bf16_f32 v78, v68, v69
  v_cvt_pk_bf16_f32 v79, v70, v71
  ds_write_b128 v9, v[76:79] offset:8448
  s_waitcnt lgkmcnt(0)
  ds_read_b128 v[96:99], v10 offset:8448
  ds_read_b128 v[100:103], v10 offset:8512
  ds_read_b128 v[104:107], v10 offset:8576
  ds_read_b128 v[108:111], v10 offset:8640
  s_waitcnt lgkmcnt(3)
  v_mfma_f32_16x16x32_bf16 v[112:115], v[96:99], v[228:231], 0
  v_mfma_f32_16x16x32_bf16 v[116:119], v[96:99], v[232:235], 0
  v_mfma_f32_16x16x32_bf16 v[120:123], v[96:99], v[236:239], 0
  v_mfma_f32_16x16x32_bf16 v[124:127], v[96:99], v[240:243], 0
  s_waitcnt lgkmcnt(2)
  v_mfma_f32_16x16x32_bf16 v[112:115], v[100:103], v[164:167], v[112:115]
  v_mfma_f32_16x16x32_bf16 v[116:119], v[100:103], v[168:171], v[116:119]
  v_mfma_f32_16x16x32_bf16 v[120:123], v[100:103], v[172:175], v[120:123]
  v_mfma_f32_16x16x32_bf16 v[124:127], v[100:103], v[176:179], v[124:127]
  s_waitcnt lgkmcnt(1)
  v_mfma_f32_16x16x32_bf16 v[112:115], v[104:107], v[180:183], v[112:115]
  v_mfma_f32_16x16x32_bf16 v[116:119], v[104:107], v[184:187], v[116:119]
  v_mfma_f32_16x16x32_bf16 v[120:123], v[104:107], v[188:191], v[120:123]
  v_mfma_f32_16x16x32_bf16 v[124:127], v[104:107], v[192:195], v[124:127]
  s_waitcnt lgkmcnt(0)
  v_mfma_f32_16x16x32_bf16 v[112:115], v[108:111], v[196:199], v[112:115]
  v_mfma_f32_16x16x32_bf16 v[116:119], v[108:111], v[200:203], v[116:119]
  v_mfma_f32_16x16x32_bf16 v[120:123], v[108:111], v[204:207], v[120:123]
  v_mfma_f32_16x16x32_bf16 v[124:127], v[108:111], v[208:211], v[124:127]
  v_and_b32 v13, 3, v1
  v_lshlrev_b32 v13, 8, v13
  v_lshrrev_b32 v14, 2, v1
  v_lshl_add_u32 v13, v14, 4, v13
  s_lshl_b32 s47, s3, 2
  v_add_u32 v13, s47, v13
  v_cmp_u_f32 vcc, v112, v113
  v_cmp_u_f32 s[50:51], v114, v115
  s_nop 0
  s_or_b64 vcc, vcc, s[50:51]
  s_cmp_eq_u32 s65, 0
  s_cbranch_scc1 L_bok
  s_cbranch_vccnz L_binit
L_bok:
  s_mov_b64 exec, 0xffff
  ds_write_b128 v11, v[112:115] offset:12544
  ds_write_b128 v11, v[116:119] offset:12800
  ds_write_b128 v11, v[120:123] offset:13056
  ds_write_b128 v11, v[124:127] offset:13312
  s_mov_b64 exec, -1
  s_lshr_b32 s47, s43, 1
  s_lshl_b32 s47, s47, 13
  s_lshl_b32 s48, s42, 10
  s_add_u32 s47, s47, s48
  s_lshl_b32 s48, s3, 8
  s_add_u32 s47, s47, s48
  s_and_b32 s48, s43, 1
  s_lshl_b32 s48, s48, 7
  s_add_u32 s47, s47, s48
  s_add_u32 s47, s47, 1703936
  v_lshl_add_u32 v14, v1, 1, s47
  s_mov_b32 s50, 0x01010101
  s_mov_b32 s51, 0x01010101
  s_waitcnt lgkmcnt(0)
  s_barrier
  ds_read_b32 v32, v13 offset:12544
  ds_read_b32 v33, v13 offset:13568
  ds_read_b32 v34, v13 offset:14592
  ds_read_b32 v35, v13 offset:15616
  s_waitcnt lgkmcnt(0)
  v_add_f32 v32, v32, v33
  v_add_f32 v34, v34, v35
  v_add_f32 v32, v32, v34
  s_nop 1
  v_mov_b32_dpp v33, v32 quad_perm:[1,0,3,2] row_mask:0xf bank_mask:0xf
  v_cvt_pk_bf16_f32 v32, v32, v33
  s_nop 1
  v_mov_b32_dpp v33, v32 row_shl:2 row_mask:0xf bank_mask:0xf
  v_mov_b32_dpp v34, v32 row_shl:4 row_mask:0xf bank_mask:0xf
  v_mov_b32_dpp v35, v32 row_shl:6 row_mask:0xf bank_mask:0xf
  s_mov_b64 exec, s[50:51]
  global_store_dwordx4 v14, v[32:35], s[26:27] sc1
  s_branch L_done
L_roleC:
  v_mul_u32_u24 v15, 28672, v3
  v_lshl_add_u32 v15, v2, 2, v15
  s_mul_i32 s48, s3, 458752
  s_lshl_b32 s47, s54, 6
  s_add_u32 s48, s48, s47
  v_add_u32 v15, s48, v15
  s_mov_b32 s56, s16
  s_mov_b32 s57, s17
  s_mov_b32 s58, 1835008
  s_mov_b32 s59, 0x20000
  s_mov_b32 s28, s18
  s_mov_b32 s29, s19
  s_mov_b32 s30, 1835008
  s_mov_b32 s31, 0x20000
  s_mov_b32 s48, 0
  buffer_load_dword v100, v15, s[56:59], s48 offen nt
  s_mov_b32 s48, 3584
  buffer_load_dword v101, v15, s[56:59], s48 offen nt
  s_mov_b32 s48, 7168
  buffer_load_dword v102, v15, s[56:59], s48 offen nt
  s_mov_b32 s48, 10752
  buffer_load_dword v103, v15, s[56:59], s48 offen nt
  s_mov_b32 s48, 14336
  buffer_load_dword v104, v15, s[56:59], s48 offen nt
  s_mov_b32 s48, 17920
  buffer_load_dword v105, v15, s[56:59], s48 offen nt
  s_mov_b32 s48, 21504
  buffer_load_dword v106, v15, s[56:59], s48 offen nt
  s_mov_b32 s48, 25088
  buffer_load_dword v107, v15, s[56:59], s48 offen nt
  s_mov_b32 s48, 114688
  buffer_load_dword v108, v15, s[56:59], s48 offen nt
  s_mov_b32 s48, 118272
  buffer_load_dword v109, v15, s[56:59], s48 offen nt
  s_mov_b32 s48, 121856
  buffer_load_dword v110, v15, s[56:59], s48 offen nt
  s_mov_b32 s48, 125440
  buffer_load_dword v111, v15, s[56:59], s48 offen nt
  s_mov_b32 s48, 129024
  buffer_load_dword v112, v15, s[56:59], s48 offen nt
  s_mov_b32 s48, 132608
  buffer_load_dword v113, v15, s[56:59], s48 offen nt
  s_mov_b32 s48, 136192
  buffer_load_dword v114, v15, s[56:59], s48 offen nt
  s_mov_b32 s48, 139776
  buffer_load_dword v115, v15, s[56:59], s48 offen nt
  s_mov_b32 s48, 229376
  buffer_load_dword v116, v15, s[56:59], s48 offen nt
  s_mov_b32 s48, 232960
  buffer_load_dword v117, v15, s[56:59], s48 offen nt
  s_mov_b32 s48, 236544
  buffer_load_dword v118, v15, s[56:59], s48 offen nt
  s_mov_b32 s48, 240128
  buffer_load_dword v119, v15, s[56:59], s48 offen nt
  s_mov_b32 s48, 243712
  buffer_load_dword v120, v15, s[56:59], s48 offen nt
  s_mov_b32 s48, 247296
  buffer_load_dword v121, v15, s[56:59], s48 offen nt
  s_mov_b32 s48, 250880
  buffer_load_dword v122, v15, s[56:59], s48 offen nt
  s_mov_b32 s48, 254464
  buffer_load_dword v123, v15, s[56:59], s48 offen nt
  s_mov_b32 s48, 344064
  buffer_load_dword v124, v15, s[56:59], s48 offen nt
  s_mov_b32 s48, 347648
  buffer_load_dword v125, v15, s[56:59], s48 offen nt
  s_mov_b32 s48, 351232
  buffer_load_dword v126, v15, s[56:59], s48 offen nt
  s_mov_b32 s48, 354816
  buffer_load_dword v127, v15, s[56:59], s48 offen nt
  s_mov_b32 s48, 358400
  buffer_load_dword v128, v15, s[56:59], s48 offen nt
  s_mov_b32 s48, 361984
  buffer_load_dword v129, v15, s[56:59], s48 offen nt
  s_mov_b32 s48, 365568
  buffer_load_dword v130, v15, s[56:59], s48 offen nt
  s_mov_b32 s48, 369152
  buffer_load_dword v131, v15, s[56:59], s48 offen nt
  s_mov_b32 s48, 0
  buffer_load_dword v132, v15, s[28:31], s48 offen nt
  s_mov_b32 s48, 3584
  buffer_load_dword v133, v15, s[28:31], s48 offen nt
  s_mov_b32 s48, 7168
  buffer_load_dword v134, v15, s[28:31], s48 offen nt
  s_mov_b32 s48, 10752
  buffer_load_dword v135, v15, s[28:31], s48 offen nt
  s_mov_b32 s48, 14336
  buffer_load_dword v136, v15, s[28:31], s48 offen nt
  s_mov_b32 s48, 17920
  buffer_load_dword v137, v15, s[28:31], s48 offen nt
  s_mov_b32 s48, 21504
  buffer_load_dword v138, v15, s[28:31], s48 offen nt
  s_mov_b32 s48, 25088
  buffer_load_dword v139, v15, s[28:31], s48 offen nt
  s_mov_b32 s48, 114688
  buffer_load_dword v140, v15, s[28:31], s48 offen nt
  s_mov_b32 s48, 118272
  buffer_load_dword v141, v15, s[28:31], s48 offen nt
  s_mov_b32 s48, 121856
  buffer_load_dword v142, v15, s[28:31], s48 offen nt
  s_mov_b32 s48, 125440
  buffer_load_dword v143, v15, s[28:31], s48 offen nt
  s_mov_b32 s48, 129024
  buffer_load_dword v144, v15, s[28:31], s48 offen nt
  s_mov_b32 s48, 132608
  buffer_load_dword v145, v15, s[28:31], s48 offen nt
  s_mov_b32 s48, 136192
  buffer_load_dword v146, v15, s[28:31], s48 offen nt
  s_mov_b32 s48, 139776
  buffer_load_dword v147, v15, s[28:31], s48 offen nt
  s_mov_b32 s48, 229376
  buffer_load_dword v148, v15, s[28:31], s48 offen nt
  s_mov_b32 s48, 232960
  buffer_load_dword v149, v15, s[28:31], s48 offen nt
  s_mov_b32 s48, 236544
  buffer_load_dword v150, v15, s[28:31], s48 offen nt
  s_mov_b32 s48, 240128
  buffer_load_dword v151, v15, s[28:31], s48 offen nt
  s_mov_b32 s48, 243712
  buffer_load_dword v152, v15, s[28:31], s48 offen nt
  s_mov_b32 s48, 247296
  buffer_load_dword v153, v15, s[28:31], s48 offen nt
  s_mov_b32 s48, 250880
  buffer_load_dword v154, v15, s[28:31], s48 offen nt
  s_mov_b32 s48, 254464
  buffer_load_dword v155, v15, s[28:31], s48 offen nt
  s_mov_b32 s48, 344064
  buffer_load_dword v156, v15, s[28:31], s48 offen nt
  s_mov_b32 s48, 347648
  buffer_load_dword v157, v15, s[28:31], s48 offen nt
  s_mov_b32 s48, 351232
  buffer_load_dword v158, v15, s[28:31], s48 offen nt
  s_mov_b32 s48, 354816
  buffer_load_dword v159, v15, s[28:31], s48 offen nt
  s_mov_b32 s48, 358400
  buffer_load_dword v160, v15, s[28:31], s48 offen nt
  s_mov_b32 s48, 361984
  buffer_load_dword v161, v15, s[28:31], s48 offen nt
  s_mov_b32 s48, 365568
  buffer_load_dword v162, v15, s[28:31], s48 offen nt
  s_mov_b32 s48, 369152
  buffer_load_dword v163, v15, s[28:31], s48 offen nt
  v_lshlrev_b32 v15, 13, v3
  v_lshl_add_u32 v15, v2, 4, v15
  s_lshl_b32 s48, s54, 15
  s_lshl_b32 s47, s3, 8
  s_add_u32 s48, s48, s47
  v_add_u32 v15, s48, v15
  v_add_u32 v10, 0x1000, v15
  global_load_dwordx4 v[164:167], v15, s[20:21] offset:0 nt
  global_load_dwordx4 v[168:171], v15, s[20:21] offset:1024 nt
  global_load_dwordx4 v[172:175], v15, s[20:21] offset:2048 nt
  global_load_dwordx4 v[176:179], v15, s[20:21] offset:3072 nt
  global_load_dwordx4 v[180:183], v10, s[20:21] offset:0 nt
  global_load_dwordx4 v[184:187], v10, s[20:21] offset:1024 nt
  global_load_dwordx4 v[188:191], v10, s[20:21] offset:2048 nt
  global_load_dwordx4 v[192:195], v10, s[20:21] offset:3072 nt
  v_lshlrev_b32 v15, 10, v3
  v_lshl_add_u32 v15, v2, 4, v15
  s_lshl_b32 s47, s3, 8
  v_add_u32 v15, s47, v15
  global_load_dwordx4 v[196:199], v15, s[4:5]
  v_mov_b32 v20, 0x3f803f80
  v_mov_b32 v21, 0x3f803f80
  v_lshlrev_b32 v9, 3, v1
  ds_write_b64 v9, v[20:21] offset:27136
  s_waitcnt vmcnt(57)
  v_perm_b32 v84, v101, v100, s40
  v_perm_b32 v85, v103, v102, s40
  v_perm_b32 v86, v105, v104, s40
  v_perm_b32 v87, v107, v106, s40
  v_perm_b32 v88, v101, v100, s41
  v_perm_b32 v89, v103, v102, s41
  v_perm_b32 v90, v105, v104, s41
  v_perm_b32 v91, v107, v106, s41
  v_perm_b32 v100, v109, v108, s40
  v_perm_b32 v101, v111, v110, s40
  v_perm_b32 v102, v113, v112, s40
  v_perm_b32 v103, v115, v114, s40
  v_perm_b32 v104, v109, v108, s41
  v_perm_b32 v105, v111, v110, s41
  v_perm_b32 v106, v113, v112, s41
  v_perm_b32 v107, v115, v114, s41
  s_waitcnt vmcnt(41)
  v_perm_b32 v108, v117, v116, s40
  v_perm_b32 v109, v119, v118, s40
  v_perm_b32 v110, v121, v120, s40
  v_perm_b32 v111, v123, v122, s40
  v_perm_b32 v112, v117, v116, s41
  v_perm_b32 v113, v119, v118, s41
  v_perm_b32 v114, v121, v120, s41
  v_perm_b32 v115, v123, v122, s41
  v_perm_b32 v116, v125, v124, s40
  v_perm_b32 v117, v127, v126, s40
  v_perm_b32 v118, v129, v128, s40
  v_perm_b32 v119, v131, v130, s40
  v_perm_b32 v120, v125, v124, s41
  v_perm_b32 v121, v127, v126, s41
  v_perm_b32 v122, v129, v128, s41
  v_perm_b32 v123, v131, v130, s41
  s_waitcnt vmcnt(25)
  v_perm_b32 v124, v133, v132, s40
  v_perm_b32 v125, v135, v134, s40
  v_perm_b32 v126, v137, v136, s40
  v_perm_b32 v127, v139, v138, s40
  v_perm_b32 v128, v133, v132, s41
  v_perm_b32 v129, v135, v134, s41
  v_perm_b32 v130, v137, v136, s41
  v_perm_b32 v131, v139, v138, s41
  v_perm_b32 v132, v141, v140, s40
  v_perm_b32 v133, v143, v142, s40
  v_perm_b32 v134, v145, v144, s40
  v_perm_b32 v135, v147, v146, s40
  v_perm_b32 v136, v141, v140, s41
  v_perm_b32 v137, v143, v142, s41
  v_perm_b32 v138, v145, v144, s41
  v_perm_b32 v139, v147, v146, s41
  s_waitcnt vmcnt(9)
  v_perm_b32 v140, v149, v148, s40
  v_perm_b32 v141, v151, v150, s40
  v_perm_b32 v142, v153, v152, s40
  v_perm_b32 v143, v155, v154, s40
  v_perm_b32 v144, v149, v148, s41
  v_perm_b32 v145, v151, v150, s41
  v_perm_b32 v146, v153, v152, s41
  v_perm_b32 v147, v155, v154, s41
  v_perm_b32 v148, v157, v156, s40
  v_perm_b32 v149, v159, v158, s40
  v_perm_b32 v150, v161, v160, s40
  v_perm_b32 v151, v163, v162, s40
  v_perm_b32 v152, v157, v156, s41
  v_perm_b32 v153, v159, v158, s41
  v_perm_b32 v154, v161, v160, s41
  v_perm_b32 v155, v163, v162, s41
  s_waitcnt vmcnt(0)
  v_perm_b32 v200, v168, v164, s40
  v_perm_b32 v201, v176, v172, s40
  v_perm_b32 v202, v184, v180, s40
  v_perm_b32 v203, v192, v188, s40
  v_perm_b32 v204, v168, v164, s41
  v_perm_b32 v205, v176, v172, s41
  v_perm_b32 v206, v184, v180, s41
  v_perm_b32 v207, v192, v188, s41
  v_perm_b32 v208, v169, v165, s40
  v_perm_b32 v209, v177, v173, s40
  v_perm_b32 v210, v185, v181, s40
  v_perm_b32 v211, v193, v189, s40
  v_perm_b32 v212, v169, v165, s41
  v_perm_b32 v213, v177, v173, s41
  v_perm_b32 v214, v185, v181, s41
  v_perm_b32 v215, v193, v189, s41
  v_perm_b32 v216, v170, v166, s40
  v_perm_b32 v217, v178, v174, s40
  v_perm_b32 v218, v186, v182, s40
  v_perm_b32 v219, v194, v190, s40
  v_perm_b32 v220, v170, v166, s41
  v_perm_b32 v221, v178, v174, s41
  v_perm_b32 v222, v186, v182, s41
  v_perm_b32 v223, v194, v190, s41
  v_perm_b32 v224, v171, v167, s40
  v_perm_b32 v225, v179, v175, s40
  v_perm_b32 v226, v187, v183, s40
  v_perm_b32 v227, v195, v191, s40
  v_perm_b32 v228, v171, v167, s41
  v_perm_b32 v229, v179, v175, s41
  v_perm_b32 v230, v187, v183, s41
  v_perm_b32 v231, v195, v191, s41
  v_lshlrev_b32 v232, 16, v196
  v_and_b32 v233, 0xffff0000, v196
  v_lshlrev_b32 v234, 16, v197
  v_and_b32 v235, 0xffff0000, v197
  v_lshlrev_b32 v236, 16, v198
  v_and_b32 v237, 0xffff0000, v198
  v_lshlrev_b32 v238, 16, v199
  v_and_b32 v239, 0xffff0000, v199
  s_mov_b32 s62, 0
L_roleC2:
  s_lshl_b32 s47, s3, 13
  s_add_u32 s47, s47, 1703936
  v_lshl_add_u32 v6, v1, 4, s47
  v_add_u32 v7, 0x1000, v6
  v_lshlrev_b32 v9, 10, v3
  v_lshl_add_u32 v9, v2, 4, v9
  s_lshl_b32 s47, s3, 8
  v_add_u32 v9, s47, v9
  v_add_u32 v9, 23040, v9
  v_lshlrev_b32 v10, 10, v4
  v_lshl_add_u32 v10, v3, 4, v10
  v_add_u32 v10, s47, v10
  v_add_u32 v10, 23040, v10
  v_lshlrev_b32 v11, 4, v3
  v_add_u32 v11, 27136, v11
  v_cmp_eq_u32 vcc, 4, v2
  s_nop 1
  v_cndmask_b32 v10, v10, v11, vcc
  s_mul_i32 s47, s3, 2560
  v_lshl_add_u32 v11, v1, 4, s47
  s_mov_b32 s65, 262144
  s_cmp_eq_u32 s62, 1
  s_cbranch_scc1 L_cgo
L_cinit:
  s_mov_b32 s61, 0xff
  v_mov_b32 v64, v232
  v_mov_b32 v65, v233
  v_mov_b32 v66, v234
  v_mov_b32 v67, v235
  v_mov_b32 v68, v236
  v_mov_b32 v69, v237
  v_mov_b32 v70, v238
  v_mov_b32 v71, v239
L_cpoll:
  s_bitcmp1_b32 s61, 0
  s_cbranch_scc0 L_cl0
  global_load_dwordx4 v[32:35], v6, s[26:27] offset:0 sc1
L_cl0:
  s_bitcmp1_b32 s61, 1
  s_cbranch_scc0 L_cl1
  global_load_dwordx4 v[36:39], v6, s[26:27] offset:1024 sc1
L_cl1:
  s_bitcmp1_b32 s61, 2
  s_cbranch_scc0 L_cl2
  global_load_dwordx4 v[40:43], v6, s[26:27] offset:2048 sc1
L_cl2:
  s_bitcmp1_b32 s61, 3
  s_cbranch_scc0 L_cl3
  global_load_dwordx4 v[44:47], v6, s[26:27] offset:3072 sc1
L_cl3:
  s_bitcmp1_b32 s61, 4
  s_cbranch_scc0 L_cl4
  global_load_dwordx4 v[48:51], v7, s[26:27] offset:0 sc1
L_cl4:
  s_bitcmp1_b32 s61, 5
  s_cbranch_scc0 L_cl5
  global_load_dwordx4 v[52:55], v7, s[26:27] offset:1024 sc1
L_cl5:
  s_bitcmp1_b32 s61, 6
  s_cbranch_scc0 L_cl6
  global_load_dwordx4 v[56:59], v7, s[26:27] offset:2048 sc1
L_cl6:
  s_bitcmp1_b32 s61, 7
  s_cbranch_scc0 L_cl7
  global_load_dwordx4 v[60:63], v7, s[26:27] offset:3072 sc1
L_cl7:
  s_waitcnt vmcnt(0)
  s_bitcmp1_b32 s61, 0
  s_cbranch_scc0 L_cn0
  v_cmp_eq_u32 vcc, -1, v32
  s_nop 0
  s_cbranch_vccnz L_cn0
  s_bitset0_b32 s61, 0
  v_lshlrev_b32 v72, 16, v32
  v_and_b32 v73, 0xffff0000, v32
  v_lshlrev_b32 v74, 16, v33
  v_and_b32 v75, 0xffff0000, v33
  v_lshlrev_b32 v76, 16, v34
  v_and_b32 v77, 0xffff0000, v34
  v_lshlrev_b32 v78, 16, v35
  v_and_b32 v79, 0xffff0000, v35
  v_pk_add_f32 v[64:65], v[64:65], v[72:73]
  v_pk_add_f32 v[66:67], v[66:67], v[74:75]
  v_pk_add_f32 v[68:69], v[68:69], v[76:77]
  v_pk_add_f32 v[70:71], v[70:71], v[78:79]
L_cn0:
  s_bitcmp1_b32 s61, 1
  s_cbranch_scc0 L_cn1
  v_cmp_eq_u32 vcc, -1, v36
  s_nop 0
  s_cbranch_vccnz L_cn1
  s_bitset0_b32 s61, 1
  v_lshlrev_b32 v72, 16, v36
  v_and_b32 v73, 0xffff0000, v36
  v_lshlrev_b32 v74, 16, v37
  v_and_b32 v75, 0xffff0000, v37
  v_lshlrev_b32 v76, 16, v38
  v_and_b32 v77, 0xffff0000, v38
  v_lshlrev_b32 v78, 16, v39
  v_and_b32 v79, 0xffff0000, v39
  v_pk_add_f32 v[64:65], v[64:65], v[72:73]
  v_pk_add_f32 v[66:67], v[66:67], v[74:75]
  v_pk_add_f32 v[68:69], v[68:69], v[76:77]
  v_pk_add_f32 v[70:71], v[70:71], v[78:79]
L_cn1:
  s_bitcmp1_b32 s61, 2
  s_cbranch_scc0 L_cn2
  v_cmp_eq_u32 vcc, -1, v40
  s_nop 0
  s_cbranch_vccnz L_cn2
  s_bitset0_b32 s61, 2
  v_lshlrev_b32 v72, 16, v40
  v_and_b32 v73, 0xffff0000, v40
  v_lshlrev_b32 v74, 16, v41
  v_and_b32 v75, 0xffff0000, v41
  v_lshlrev_b32 v76, 16, v42
  v_and_b32 v77, 0xffff0000, v42
  v_lshlrev_b32 v78, 16, v43
  v_and_b32 v79, 0xffff0000, v43
  v_pk_add_f32 v[64:65], v[64:65], v[72:73]
  v_pk_add_f32 v[66:67], v[66:67], v[74:75]
  v_pk_add_f32 v[68:69], v[68:69], v[76:77]
  v_pk_add_f32 v[70:71], v[70:71], v[78:79]
L_cn2:
  s_bitcmp1_b32 s61, 3
  s_cbranch_scc0 L_cn3
  v_cmp_eq_u32 vcc, -1, v44
  s_nop 0
  s_cbranch_vccnz L_cn3
  s_bitset0_b32 s61, 3
  v_lshlrev_b32 v72, 16, v44
  v_and_b32 v73, 0xffff0000, v44
  v_lshlrev_b32 v74, 16, v45
  v_and_b32 v75, 0xffff0000, v45
  v_lshlrev_b32 v76, 16, v46
  v_and_b32 v77, 0xffff0000, v46
  v_lshlrev_b32 v78, 16, v47
  v_and_b32 v79, 0xffff0000, v47
  v_pk_add_f32 v[64:65], v[64:65], v[72:73]
  v_pk_add_f32 v[66:67], v[66:67], v[74:75]
  v_pk_add_f32 v[68:69], v[68:69], v[76:77]
  v_pk_add_f32 v[70:71], v[70:71], v[78:79]
L_cn3:
  s_bitcmp1_b32 s61, 4
  s_cbranch_scc0 L_cn4
  v_cmp_eq_u32 vcc, -1, v48
  s_nop 0
  s_cbranch_vccnz L_cn4
  s_bitset0_b32 s61, 4
  v_lshlrev_b32 v72, 16, v48
  v_and_b32 v73, 0xffff0000, v48
  v_lshlrev_b32 v74, 16, v49
  v_and_b32 v75, 0xffff0000, v49
  v_lshlrev_b32 v76, 16, v50
  v_and_b32 v77, 0xffff0000, v50
  v_lshlrev_b32 v78, 16, v51
  v_and_b32 v79, 0xffff0000, v51
  v_pk_add_f32 v[64:65], v[64:65], v[72:73]
  v_pk_add_f32 v[66:67], v[66:67], v[74:75]
  v_pk_add_f32 v[68:69], v[68:69], v[76:77]
  v_pk_add_f32 v[70:71], v[70:71], v[78:79]
L_cn4:
  s_bitcmp1_b32 s61, 5
  s_cbranch_scc0 L_cn5
  v_cmp_eq_u32 vcc, -1, v52
  s_nop 0
  s_cbranch_vccnz L_cn5
  s_bitset0_b32 s61, 5
  v_lshlrev_b32 v72, 16, v52
  v_and_b32 v73, 0xffff0000, v52
  v_lshlrev_b32 v74, 16, v53
  v_and_b32 v75, 0xffff0000, v53
  v_lshlrev_b32 v76, 16, v54
  v_and_b32 v77, 0xffff0000, v54
  v_lshlrev_b32 v78, 16, v55
  v_and_b32 v79, 0xffff0000, v55
  v_pk_add_f32 v[64:65], v[64:65], v[72:73]
  v_pk_add_f32 v[66:67], v[66:67], v[74:75]
  v_pk_add_f32 v[68:69], v[68:69], v[76:77]
  v_pk_add_f32 v[70:71], v[70:71], v[78:79]
L_cn5:
  s_bitcmp1_b32 s61, 6
  s_cbranch_scc0 L_cn6
  v_cmp_eq_u32 vcc, -1, v56
  s_nop 0
  s_cbranch_vccnz L_cn6
  s_bitset0_b32 s61, 6
  v_lshlrev_b32 v72, 16, v56
  v_and_b32 v73, 0xffff0000, v56
  v_lshlrev_b32 v74, 16, v57
  v_and_b32 v75, 0xffff0000, v57
  v_lshlrev_b32 v76, 16, v58
  v_and_b32 v77, 0xffff0000, v58
  v_lshlrev_b32 v78, 16, v59
  v_and_b32 v79, 0xffff0000, v59
  v_pk_add_f32 v[64:65], v[64:65], v[72:73]
  v_pk_add_f32 v[66:67], v[66:67], v[74:75]
  v_pk_add_f32 v[68:69], v[68:69], v[76:77]
  v_pk_add_f32 v[70:71], v[70:71], v[78:79]
L_cn6:
  s_bitcmp1_b32 s61, 7
  s_cbranch_scc0 L_cn7
  v_cmp_eq_u32 vcc, -1, v60
  s_nop 0
  s_cbranch_vccnz L_cn7
  s_bitset0_b32 s61, 7
  v_lshlrev_b32 v72, 16, v60
  v_and_b32 v73, 0xffff0000, v60
  v_lshlrev_b32 v74, 16, v61
  v_and_b32 v75, 0xffff0000, v61
  v_lshlrev_b32 v76, 16, v62
  v_and_b32 v77, 0xffff0000, v62
  v_lshlrev_b32 v78, 16, v63
  v_and_b32 v79, 0xffff0000, v63
  v_pk_add_f32 v[64:65], v[64:65], v[72:73]
  v_pk_add_f32 v[66:67], v[66:67], v[74:75]
  v_pk_add_f32 v[68:69], v[68:69], v[76:77]
  v_pk_add_f32 v[70:71], v[70:71], v[78:79]
L_cn7:
  s_sub_u32 s65, s65, 1
  s_cmp_eq_u32 s65, 0
  s_cbranch_scc1 L_cgo
  s_cmp_lg_u32 s61, 0
  s_cbranch_scc1 L_cpoll
L_cgo:
  v_cvt_pk_bf16_f32 v76, v64, v65
  v_cvt_pk_bf16_f32 v77, v66, v67
  v_cvt_pk_bf16_f32 v78, v68, v69
  v_cvt_pk_bf16_f32 v79, v70, v71
  ds_write_b128 v9, v[76:79]
  s_waitcnt lgkmcnt(0)
  ds_read_b128 v[16:19], v10 offset:0
  ds_read_b128 v[20:23], v10 offset:64
  ds_read_b128 v[24:27], v10 offset:128
  ds_read_b128 v[28:31], v10 offset:192
  s_waitcnt lgkmcnt(3)
  v_mfma_f32_16x16x32_bf16 v[64:67], v[16:19], v[84:87], 0
  v_mfma_f32_16x16x32_bf16 v[68:71], v[16:19], v[88:91], 0
  v_mfma_f32_16x16x32_bf16 v[72:75], v[16:19], v[124:127], 0
  v_mfma_f32_16x16x32_bf16 v[76:79], v[16:19], v[128:131], 0
  v_mfma_f32_16x16x32_bf16 v[80:83], v[16:19], v[16:19], 0
  s_waitcnt lgkmcnt(2)
  v_mfma_f32_16x16x32_bf16 v[64:67], v[20:23], v[100:103], v[64:67]
  v_mfma_f32_16x16x32_bf16 v[68:71], v[20:23], v[104:107], v[68:71]
  v_mfma_f32_16x16x32_bf16 v[72:75], v[20:23], v[132:135], v[72:75]
  v_mfma_f32_16x16x32_bf16 v[76:79], v[20:23], v[136:139], v[76:79]
  v_mfma_f32_16x16x32_bf16 v[80:83], v[20:23], v[20:23], v[80:83]
  s_waitcnt lgkmcnt(1)
  v_mfma_f32_16x16x32_bf16 v[64:67], v[24:27], v[108:111], v[64:67]
  v_mfma_f32_16x16x32_bf16 v[68:71], v[24:27], v[112:115], v[68:71]
  v_mfma_f32_16x16x32_bf16 v[72:75], v[24:27], v[140:143], v[72:75]
  v_mfma_f32_16x16x32_bf16 v[76:79], v[24:27], v[144:147], v[76:79]
  v_mfma_f32_16x16x32_bf16 v[80:83], v[24:27], v[24:27], v[80:83]
  s_waitcnt lgkmcnt(0)
  v_mfma_f32_16x16x32_bf16 v[64:67], v[28:31], v[116:119], v[64:67]
  v_mfma_f32_16x16x32_bf16 v[68:71], v[28:31], v[120:123], v[68:71]
  v_mfma_f32_16x16x32_bf16 v[72:75], v[28:31], v[148:151], v[72:75]
  v_mfma_f32_16x16x32_bf16 v[76:79], v[28:31], v[152:155], v[76:79]
  v_mfma_f32_16x16x32_bf16 v[80:83], v[28:31], v[28:31], v[80:83]
  v_lshrrev_b32 v12, 5, v0
  v_and_b32 v13, 31, v0
  v_lshrrev_b32 v14, 1, v13
  v_and_b32 v15, 1, v13
  v_lshlrev_b32 v32, 4, v14
  v_lshl_add_u32 v32, v15, 9, v32
  v_add_u32 v33, 0x100, v32
  v_lshl_add_u32 v32, v12, 2, v32
  v_mul_u32_u24 v34, 20, v12
  v_lshlrev_b32 v35, 4, v12
  v_cmp_u_f32 vcc, v80, v81
  v_cmp_u_f32 s[50:51], v82, v83
  s_nop 0
  s_or_b64 vcc, vcc, s[50:51]
  s_cmp_eq_u32 s62, 1
  s_cbranch_scc1 L_cok2
  s_cmp_eq_u32 s65, 0
  s_cbranch_scc1 L_cok2
  s_cbranch_vccnz L_cinit
L_cok2:
  s_mov_b32 s50, -1
  s_mov_b32 s51, 0
  s_mov_b64 exec, s[50:51]
  ds_write_b128 v11, v[64:67] offset:12544
  ds_write_b128 v11, v[68:71] offset:13056
  ds_write_b128 v11, v[72:75] offset:13568
  ds_write_b128 v11, v[76:79] offset:14080
  ds_write_b128 v11, v[80:83] offset:14592
  s_mov_b64 exec, -1
  s_waitcnt lgkmcnt(0)
  s_barrier
  s_cmp_ge_u32 s3, 2
  s_cbranch_scc1 L_skipact
  ds_read_b32 v52, v34 offset:14592
  ds_read_b32 v56, v35 offset:14848
  ds_read_b32 v53, v34 offset:17152
  ds_read_b32 v57, v35 offset:17408
  ds_read_b32 v54, v34 offset:19712
  ds_read_b32 v58, v35 offset:19968
  ds_read_b32 v55, v34 offset:22272
  ds_read_b32 v59, v35 offset:22528
  ds_read_b32 v36, v32 offset:12544
  ds_read_b32 v40, v32 offset:13568
  ds_read_b32 v44, v33 offset:12544
  ds_read_b32 v48, v33 offset:13568
  ds_read_b32 v37, v32 offset:15104
  ds_read_b32 v41, v32 offset:16128
  ds_read_b32 v45, v33 offset:15104
  ds_read_b32 v49, v33 offset:16128
  ds_read_b32 v38, v32 offset:17664
  ds_read_b32 v42, v32 offset:18688
  ds_read_b32 v46, v33 offset:17664
  ds_read_b32 v50, v33 offset:18688
  ds_read_b32 v39, v32 offset:20224
  ds_read_b32 v43, v32 offset:21248
  ds_read_b32 v47, v33 offset:20224
  ds_read_b32 v51, v33 offset:21248
  s_waitcnt lgkmcnt(15)
  s_waitcnt lgkmcnt(14)
  s_waitcnt lgkmcnt(0)
  v_add_f32 v52, v52, v53
  v_add_f32 v54, v54, v55
  v_add_f32 v52, v52, v54
  v_add_f32 v56, v56, v57
  v_add_f32 v58, v58, v59
  v_add_f32 v56, v56, v58
  v_add_f32 v36, v36, v37
  v_add_f32 v38, v38, v39
  v_add_f32 v36, v36, v38
  v_add_f32 v40, v40, v41
  v_add_f32 v42, v42, v43
  v_add_f32 v40, v40, v42
  v_add_f32 v44, v44, v45
  v_add_f32 v46, v46, v47
  v_add_f32 v44, v44, v46
  v_add_f32 v48, v48, v49
  v_add_f32 v50, v50, v51
  v_add_f32 v48, v48, v50
  v_mul_f32 v56, 0x3b000000, v56
  v_mul_f32 v52, 0x3b000000, v52
  v_fma_f32 v52, -v56, v56, v52
  v_add_f32 v52, 0x3727c5ac, v52
  v_rsq_f32 v52, v52
  v_fma_f32 v36, -v56, v44, v36
  v_fma_f32 v40, -v56, v48, v40
  v_mul_f32 v36, v36, v52
  v_mul_f32 v40, v40, v52
  v_mul_f32 v37, 0xbfb8aa3b, v36
  v_exp_f32 v37, v37
  s_nop 0
  v_add_f32 v37, 1.0, v37
  v_rcp_f32 v37, v37
  s_nop 0
  v_mul_f32 v36, v36, v37
  v_mul_f32 v36, v36, v40
  v_cvt_pk_bf16_f32 v36, v36, v36
  v_lshlrev_b32 v37, 6, v12
  v_lshl_add_u32 v37, v13, 1, v37
  ds_write_b16 v37, v36 offset:22784
L_skipact:
  v_lshlrev_b32 v12, 6, v4
  v_lshl_add_u32 v12, v3, 4, v12
  s_lshl_b32 s47, s54, 13
  s_lshl_b32 s48, s3, 11
  s_add_u32 s47, s47, s48
  s_add_u32 s47, s47, 2097152
  v_add_u32 v13, s47, v12
  s_mov_b32 s50, 0x000f000f
  s_mov_b32 s51, 0x000f000f
  s_waitcnt lgkmcnt(0)
  s_barrier
  ds_read_b128 v[16:19], v12 offset:22784
  s_waitcnt lgkmcnt(0)
  v_mfma_f32_16x16x32_bf16 v[32:35], v[200:203], v[16:19], 0
  v_mfma_f32_16x16x32_bf16 v[36:39], v[204:207], v[16:19], 0
  v_mfma_f32_16x16x32_bf16 v[40:43], v[208:211], v[16:19], 0
  v_mfma_f32_16x16x32_bf16 v[44:47], v[212:215], v[16:19], 0
  v_mfma_f32_16x16x32_bf16 v[48:51], v[216:219], v[16:19], 0
  v_mfma_f32_16x16x32_bf16 v[52:55], v[220:223], v[16:19], 0
  v_mfma_f32_16x16x32_bf16 v[56:59], v[224:227], v[16:19], 0
  v_mfma_f32_16x16x32_bf16 v[60:63], v[228:231], v[16:19], 0
  s_cmp_eq_u32 s62, 1
  s_cbranch_scc1 L_cnopub
  s_mov_b64 exec, s[50:51]
  global_store_dwordx4 v13, v[32:35], s[26:27] offset:0 sc1
  global_store_dwordx4 v13, v[36:39], s[26:27] offset:256 sc1
  global_store_dwordx4 v13, v[40:43], s[26:27] offset:512 sc1
  global_store_dwordx4 v13, v[44:47], s[26:27] offset:768 sc1
  global_store_dwordx4 v13, v[48:51], s[26:27] offset:1024 sc1
  global_store_dwordx4 v13, v[52:55], s[26:27] offset:1280 sc1
  global_store_dwordx4 v13, v[56:59], s[26:27] offset:1536 sc1
  global_store_dwordx4 v13, v[60:63], s[26:27] offset:1792 sc1
  s_mov_b64 exec, -1
L_cnopub:
  s_cmp_ge_u32 s54, 32
  s_cbranch_scc1 L_cexit
  v_lshrrev_b32 v2, 4, v0
  v_and_b32 v3, 15, v0
  v_min_u32 v4, 13, v2
  v_lshlrev_b32 v4, 15, v4
  v_lshl_add_u32 v4, v3, 4, v4
  s_lshl_b32 s47, s54, 8
  s_add_u32 s47, s47, 2097152
  v_add_u32 v4, s47, v4
  v_add_u32 v5, 0x2000, v4
  v_add_u32 v6, 0x4000, v4
  v_add_u32 v7, 0x6000, v4
  s_mov_b32 s65, 262144
  s_lshr_b32 s47, s54, 3
  s_and_b32 s48, s54, 7
  s_lshl_b32 s47, s47, 7
  s_add_u32 s47, s47, s48
  v_lshrrev_b32 v26, 4, v1
  v_bfe_u32 v27, v1, 2, 2
  v_and_b32 v28, 3, v1
  v_lshlrev_b32 v25, 9, v26
  v_lshl_add_u32 v25, v27, 5, v25
  v_lshl_add_u32 v25, v28, 3, v25
  v_add_u32 v25, s47, v25
  v_lshlrev_b32 v25, 1, v25
  ds_read_u16 v24, v25 offset:23040
  s_cmp_eq_u32 s62, 1
  s_cbranch_scc1 L_fok
L_fpoll:
  global_load_dwordx4 v[8:11], v4, s[26:27] sc1
  global_load_dwordx4 v[12:15], v5, s[26:27] sc1
  global_load_dwordx4 v[16:19], v6, s[26:27] sc1
  global_load_dwordx4 v[20:23], v7, s[26:27] sc1
  s_waitcnt vmcnt(0)
  v_add_f32 v8, v8, v12
  v_add_f32 v16, v16, v20
  v_add_f32 v8, v8, v16
  v_add_f32 v9, v9, v13
  v_add_f32 v17, v17, v21
  v_add_f32 v9, v9, v17
  v_add_f32 v10, v10, v14
  v_add_f32 v18, v18, v22
  v_add_f32 v10, v10, v18
  v_add_f32 v11, v11, v15
  v_add_f32 v19, v19, v23
  v_add_f32 v11, v11, v19
  v_cmp_u_f32 vcc, v8, v9
  v_cmp_u_f32 s[50:51], v10, v11
  s_nop 0
  s_or_b64 vcc, vcc, s[50:51]
  s_sub_u32 s65, s65, 1
  s_cmp_eq_u32 s65, 0
  s_cbranch_scc1 L_fok
  s_cbranch_vccnz L_fpoll
L_fok:
  v_lshlrev_b32 v6, 4, v0
  ds_write_b128 v6, v[8:11]
  v_lshlrev_b32 v6, 2, v1
  s_waitcnt lgkmcnt(0)
  s_barrier
  s_cmp_lg_u32 s3, 0
  s_cbranch_scc1 L_cexit
  ds_read_b32 v8, v6 offset:0
  ds_read_b32 v9, v6 offset:256
  ds_read_b32 v10, v6 offset:512
  ds_read_b32 v11, v6 offset:768
  ds_read_b32 v12, v6 offset:1024
  ds_read_b32 v13, v6 offset:1280
  ds_read_b32 v14, v6 offset:1536
  ds_read_b32 v15, v6 offset:1792
  ds_read_b32 v16, v6 offset:2048
  ds_read_b32 v17, v6 offset:2304
  ds_read_b32 v18, v6 offset:2560
  ds_read_b32 v19, v6 offset:2816
  ds_read_b32 v20, v6 offset:3072
  ds_read_b32 v21, v6 offset:3328
  v_lshlrev_b32 v24, 16, v24
  s_waitcnt lgkmcnt(0)
  v_add_f32 v8, v8, v15
  v_add_f32 v9, v9, v16
  v_add_f32 v10, v10, v17
  v_add_f32 v11, v11, v18
  v_add_f32 v12, v12, v19
  v_add_f32 v13, v13, v20
  v_add_f32 v14, v14, v21
  v_add_f32 v8, v8, v11
  v_add_f32 v9, v9, v12
  v_add_f32 v10, v10, v13
  v_add_f32 v8, v8, v14
  v_add_f32 v9, v9, v10
  v_add_f32 v8, v8, v9
  v_add_f32 v8, v8, v24
  v_cvt_pk_bf16_f32 v8, v8, v8
  s_cmp_eq_u32 s62, 1
  s_cbranch_scc1 L_cexit
  global_store_short v25, v8, s[22:23]
  s_cmp_lg_u32 s54, 0
  s_cbranch_scc1 L_fend
  v_mov_b32 v9, 0
  v_mov_b32 v10, s52
  s_mov_b64 exec, 1
  global_store_dword v9, v10, s[26:27] sc1
L_fend:
  s_branch L_done
L_cexit:
  s_cmp_eq_u32 s62, 1
  s_cbranch_scc0 L_done
  s_mov_b32 s62, 0
  v_and_b32 v2, 15, v1
  v_lshrrev_b32 v3, 4, v1
  v_and_b32 v4, 3, v1
  s_branch L_roleC2
L_done:
  s_endpgm
L_codeend:
  s_endpgm
.section .rodata,"a"
.p2align 6
.amdhsa_kernel sequential_preLN__gqa_block_cached__swiglu_ffn__decode_kernel
  .amdhsa_next_free_vgpr 352
  .amdhsa_next_free_sgpr 102
  .amdhsa_accum_offset 256
  .amdhsa_group_segment_fixed_size 0
  .amdhsa_kernarg_size 96
  .amdhsa_user_sgpr_count 2
  .amdhsa_user_sgpr_kernarg_segment_ptr 1
  .amdhsa_system_sgpr_workgroup_id_x 1
.end_amdhsa_kernel
```
